```python
import torch

def _softmax(x, axis=-1):
    return torch.softmax(x, dim=axis)
def _gelu(x):
    return torch.nn.functional.gelu(x, approximate="tanh")
def _silu(x):
    return torch.nn.functional.silu(x)
def _sigmoid(x):
    return torch.sigmoid(x)
def _layernorm(x, axis=-1, eps=1e-5):
    m = x.mean(dim=axis, keepdim=True)
    v = x.var(dim=axis, keepdim=True, unbiased=False)
    return (x - m) / torch.sqrt(v + eps)
def _scatter_add(tgt, idx, src, axis=0):
    return tgt.clone().index_add_(axis, idx, src)
def _segment_sum(src, seg, n):
    out = torch.zeros((n,) + src.shape[1:], dtype=src.dtype)
    return out.index_add_(0, seg, src)
def _pad(x, pw):
    flat = tuple(v for pair in reversed(pw) for v in pair)
    return torch.nn.functional.pad(x, flat)

kernel_name = 'gated_mix__sliding_block__sliding_block__prompt'

def setup_inputs():

    _w = (lambda a: (lambda t: t.to(torch.bfloat16) if t.is_floating_point() else t)(torch.as_tensor(a)))
    def _A_setup():
        B, S, D = 1, 2048, 576
        return {
            "x": _w((lambda *s: torch.randn(*s, dtype=torch.bfloat16) * 0.05)(B, S, D)),
            "wqkv": _w((lambda *s: torch.randn(*s, dtype=torch.bfloat16) * 0.8)(D, 3 * D)),
            "wo": _w((lambda *s: torch.randn(*s, dtype=torch.bfloat16) * 0.05)(D, D)),
        }
    _A_in = _A_setup()

    def _B_setup():
        B, S, D = 1, 2048, 576
        return {
            "x": _w((lambda *s: torch.randn(*s, dtype=torch.bfloat16) * 0.05)(B, S, D)),
            "wqkv": _w((lambda *s: torch.randn(*s, dtype=torch.bfloat16) * 0.8)(D, 3 * D)),
            "wo": _w((lambda *s: torch.randn(*s, dtype=torch.bfloat16) * 0.05)(D, D)),
        }
    _B_in = _B_setup()

    return {
        "A_x": _A_in["x"],
        "A_wqkv": _A_in["wqkv"],
        "A_wo": _A_in["wo"],
        "B_x": _B_in["x"],
        "B_wqkv": _B_in["wqkv"],
        "B_wo": _B_in["wo"],
        "gate_w": _w((lambda *s: torch.randn(*s, dtype=torch.bfloat16) * 0.05)(576) * 16.0),
    }

def reference(A_x, A_wqkv, A_wo, B_x, B_wqkv, B_wo, gate_w):
    def _A_ref(x, wqkv, wo):
        B, S, D = x.shape
        H = 32; Dh = D // H; W = 256
        qkv = (lambda x, *d: x.permute(*d))((x @ wqkv).reshape(B, S, 3, H, Dh), 2, 0, 3, 1, 4)
        q, k, v = qkv[0], qkv[1], qkv[2]
        scores = torch.einsum("bhqd,bhkd->bhqk", q, k) * (Dh ** -0.5)
        idx = torch.arange(S)
        mask = (idx[:, None] - idx[None, :] >= 0) & (idx[:, None] - idx[None, :] < W)
        scores = torch.where(mask[None, None], scores, -1e9)
        p = _softmax(scores, axis=-1)
        o = torch.einsum("bhqk,bhkd->bhqd", p, v)
        return (lambda x, *d: x.permute(*d))(o, 0, 2, 1, 3).reshape(B, S, D) @ wo

    def _B_ref(x, wqkv, wo):
        B, S, D = x.shape
        H = 32; Dh = D // H; W = 256
        qkv = (lambda x, *d: x.permute(*d))((x @ wqkv).reshape(B, S, 3, H, Dh), 2, 0, 3, 1, 4)
        q, k, v = qkv[0], qkv[1], qkv[2]
        scores = torch.einsum("bhqd,bhkd->bhqk", q, k) * (Dh ** -0.5)
        idx = torch.arange(S)
        mask = (idx[:, None] - idx[None, :] >= 0) & (idx[:, None] - idx[None, :] < W)
        scores = torch.where(mask[None, None], scores, -1e9)
        p = _softmax(scores, axis=-1)
        o = torch.einsum("bhqk,bhkd->bhqd", p, v)
        return (lambda x, *d: x.permute(*d))(o, 0, 2, 1, 3).reshape(B, S, D) @ wo

    x = A_x
    g = _sigmoid((x * gate_w).sum(-1, keepdims=True))
    a = _A_ref(x, A_wqkv, A_wo)
    b = _B_ref(x, B_wqkv, B_wo)
    return g * a + (1 - g) * b
```

```asm
; @launch grid=(256,1,1) block=(256,1,1) lds=163840
.amdgcn_target "amdgcn-amd-amdhsa--gfx950"
.text
.p2align 12
.globl gated_mix__sliding_block__sliding_block__prompt_kernel
.p2align 8
.type gated_mix__sliding_block__sliding_block__prompt_kernel,@function
gated_mix__sliding_block__sliding_block__prompt_kernel:
  s_cmp_ge_u32 s2, 256
  s_cbranch_scc1 L_end
  s_load_dwordx4 s[80:83], s[0:1], 0
  s_load_dwordx8 s[88:95], s[0:1], 32
  s_getpc_b64 s[98:99]
  s_lshr_b32 s35, s2, 3
  s_lshl_b32 s38, s35, 10
  v_lshl_add_u32 v27, v0, 2, s38
  global_load_dword v216, v27, s[98:99]
  v_lshrrev_b32 v26, 6, v0
  v_and_b32 v1, 63, v0
  v_readfirstlane_b32 s28, v26
  s_and_b32 s39, s35, 7
  s_lshr_b32 s48, s2, 6
  s_lshl_b32 s34, s48, 1
  s_add_u32 s34, s34, s39
  s_cmp_ge_u32 s34, 9
  s_cselect_b32 s38, 9, 0
  s_sub_u32 s34, s34, s38
  s_and_b32 s38, s2, 4
  s_lshl_b32 s38, s38, 1
  s_add_u32 s29, s38, s39
  v_lshrrev_b32 v26, 3, v1
  v_and_b32 v27, 7, v0
  v_lshrrev_b32 v28, 1, v26
  v_xor_b32 v27, v27, v28
  v_mul_u32_u24 v26, 1152, v26
  v_lshl_add_u32 v2, v27, 4, v26
  s_lshl_b32 s38, s29, 2
  s_add_u32 s38, s38, s28
  s_mul_i32 s79, s38, 36864
  s_lshl_b32 s34, s34, 7
  s_mul_i32 s51, s28, 12288
  s_movk_i32 s38, 0x2000
  v_xor_b32 v4, 64, v2
  v_add_u32 v3, s38, v2
  v_lshl_add_u32 v4, s38, 1, v4
  v_add_u32 v5, s38, v4
  s_add_u32 s51, s51, 23040
  s_waitcnt lgkmcnt(0)
  s_add_u32 s4, s80, s79
  s_addc_u32 s5, s81, 0
  s_add_u32 s60, s4, s34
  s_addc_u32 s61, s5, 0
  s_add_u32 m0, s51, 0
  s_nop 0
  global_load_lds_dwordx4 v2, s[60:61] offset:0
  global_load_lds_dwordx4 v3, s[60:61] offset:1024
  global_load_lds_dwordx4 v4, s[60:61] offset:2048
  global_load_lds_dwordx4 v5, s[60:61] offset:3072
  s_load_dwordx2 s[96:97], s[0:1], 72
  s_load_dwordx2 s[84:85], s[0:1], 16
  v_mul_u32_u24 v31, 7282, v1
  v_lshrrev_b32 v31, 16, v31
  v_mul_u32_u24 v26, 9, v31
  v_sub_u32 v26, v1, v26
  v_lshlrev_b32 v26, 4, v26
  s_movk_i32 s35, 3456
  v_and_b32 v28, 1, v31
  v_and_b32 v29, 8, v31
  v_bfe_u32 v30, v31, 1, 2
  v_lshl_add_u32 v28, v28, 4, v29
  v_add_u32 v28, v28, v30
  v_mad_u32_u24 v6, v28, s35, v26
  v_add_u32 v31, 7, v31
  v_subrev_u32 v26, 1008, v26
  v_and_b32 v28, 1, v31
  v_and_b32 v29, 8, v31
  v_bfe_u32 v30, v31, 1, 2
  v_lshl_add_u32 v28, v28, 4, v29
  v_add_u32 v28, v28, v30
  v_mad_u32_u24 v7, v28, s35, v26
  v_add_u32 v31, 7, v31
  v_subrev_u32 v26, 1008, v26
  v_and_b32 v28, 1, v31
  v_and_b32 v29, 8, v31
  v_bfe_u32 v30, v31, 1, 2
  v_lshl_add_u32 v28, v28, 4, v29
  v_add_u32 v28, v28, v30
  v_mad_u32_u24 v8, v28, s35, v26
  s_and_b32 s30, s2, 1
  s_and_b32 s38, s2, 2
  s_lshl_b32 s38, s38, 1
  s_add_u32 s31, s38, s48
  s_lshr_b32 s38, s28, 1
  s_lshl_b32 s38, s38, 3
  s_and_b32 s39, s28, 1
  s_add_u32 s38, s38, s39
  s_mul_i32 s35, s38, 13824
  s_mul_i32 s38, s31, 144
  s_add_u32 s35, s35, s38
  s_mul_i32 s52, s28, 2304
  s_add_u32 s52, s52, 72192
  s_cmp_eq_u32 s30, 0
  s_cselect_b32 s8, s82, s88
  s_cselect_b32 s9, s83, s89
  s_add_u32 s8, s8, s35
  s_addc_u32 s9, s9, 0
  s_add_u32 s6, s8, 1152
  s_addc_u32 s7, s9, 0
  s_mul_i32 s79, s34, 1728
  s_add_u32 s60, s6, s79
  s_addc_u32 s61, s7, 0
  s_add_u32 m0, s52, 0
  s_nop 0
  global_load_lds_dwordx4 v6, s[60:61] offset:0
  global_load_lds_dwordx4 v7, s[60:61] offset:1008
  s_mov_b64 exec, 0x3ffff
  global_load_lds_dwordx4 v8, s[60:61] offset:2016
  s_mov_b64 exec, -1
  s_add_u32 s10, s8, 2304
  s_addc_u32 s11, s9, 0
  s_add_u32 s32, s34, 128
  s_cmp_eq_u32 s32, 1152
  s_cselect_b32 s32, 0, s32
  s_add_u32 s33, s32, 128
  s_cmp_eq_u32 s33, 1152
  s_cselect_b32 s33, 0, s33
  s_add_u32 s36, s33, 128
  s_cmp_eq_u32 s36, 1152
  s_cselect_b32 s36, 0, s36
  s_add_u32 s37, s36, 128
  s_cmp_eq_u32 s37, 1152
  s_cselect_b32 s37, 0, s37
  s_add_u32 s49, s37, 128
  s_cmp_eq_u32 s49, 1152
  s_cselect_b32 s49, 0, s49
  s_add_u32 s50, s49, 128
  s_cmp_eq_u32 s50, 1152
  s_cselect_b32 s50, 0, s50
  s_add_u32 s3, s50, 128
  s_cmp_eq_u32 s3, 1152
  s_cselect_b32 s3, 0, s3
  s_add_u32 s74, s3, 128
  s_cmp_eq_u32 s74, 1152
  s_cselect_b32 s74, 0, s74
  v_lshlrev_b32 v22, 4, v1
  v_mov_b32 v240, 0
  s_mov_b32 s24, s92
  s_mov_b32 s25, s93
  s_mov_b32 s26, 1152
  s_mov_b32 s27, 0x20000
  s_mul_i32 s35, s28, 288
  s_add_u32 m0, s35, 20480
  s_mov_b64 exec, 0x3ffff
  buffer_load_dwordx4 v22, s[24:27], s35 offen lds
  s_mov_b64 exec, -1
  s_waitcnt lgkmcnt(0)
  s_mov_b32 s12, s96
  s_mov_b32 s13, s97
  s_mov_b32 s14, 37748736
  s_mov_b32 s15, 0x20000
  s_add_u32 s60, s4, s32
  s_addc_u32 s61, s5, 0
  s_add_u32 m0, s51, 4096
  s_nop 0
  global_load_lds_dwordx4 v2, s[60:61] offset:0
  global_load_lds_dwordx4 v3, s[60:61] offset:1024
  global_load_lds_dwordx4 v4, s[60:61] offset:2048
  global_load_lds_dwordx4 v5, s[60:61] offset:3072
  s_mov_b32 s20, s94
  s_mov_b32 s21, s95
  s_mov_b32 s22, 2359296
  s_mov_b32 s23, 0x20000
  s_cmp_lt_u32 s28, 2
  s_cselect_b32 s16, s84, s90
  s_cselect_b32 s17, s85, s91
  s_mov_b32 s18, 663552
  s_mov_b32 s19, 0x20000
  s_mov_b32 s40, s96
  s_mov_b32 s41, s97
  s_cmp_ge_u32 s29, 1
  s_cselect_b32 s42, 40960, 0
  s_mov_b32 s43, 0x20000
  v_and_b32 v26, 15, v1
  v_lshrrev_b32 v27, 4, v1
  v_lshrrev_b32 v28, 1, v26
  v_xor_b32 v28, v27, v28
  v_and_b32 v29, 8, v26
  v_add_u32 v29, v29, v26
  v_lshlrev_b32 v29, 7, v29
  v_add_u32 v29, s51, v29
  v_lshl_add_u32 v9, v28, 4, v29
  v_xor_b32 v10, 64, v9
  v_lshlrev_b32 v241, 4, v27
  v_add_u32 v241, 20480, v241
  v_and_b32 v28, 1, v27
  v_lshlrev_b32 v28, 3, v28
  v_bfe_u32 v29, v1, 2, 2
  v_lshl_add_u32 v28, v29, 1, v28
  v_lshrrev_b32 v30, 1, v27
  v_add_u32 v28, v28, v30
  v_mul_u32_u24 v28, 144, v28
  v_add_u32 v28, 72192, v28
  v_and_b32 v30, 3, v1
  v_lshl_add_u32 v11, v30, 4, v28
  v_and_b32 v31, 2, v1
  v_lshl_add_u32 v11, v31, 2, v11
  v_add_u32 v12, 64512, v11
  v_lshl_add_u32 v15, v30, 3, v28
  v_add_u32 v16, 64512, v15
  v_and_b32 v30, 1, v1
  v_mul_u32_u24 v31, 36, v31
  v_lshl_add_u32 v30, v30, 4, v31
  v_add3_u32 v17, v30, v28, 32
  v_add_u32 v18, 64512, v17
  v_and_b32 v26, 15, v1
  v_and_b32 v28, 8, v26
  v_add_u32 v28, v28, v26
  v_lshrrev_b32 v27, 5, v1
  v_bfe_u32 v29, v1, 4, 1
  v_lshlrev_b32 v14, 12, v27
  v_lshl_add_u32 v14, v29, 9, v14
  v_lshl_add_u32 v14, v28, 4, v14
  s_lshl_b32 s35, s28, 10
  v_add_u32 v14, s35, v14
  v_lshlrev_b32 v23, 4, v0
  s_lshl_b32 s35, s28, 7
  s_add_u32 s35, s35, 22528
  v_lshlrev_b32 v247, 2, v28
  v_add_u32 v247, s35, v247
  v_mov_b32 v176, 0x3f803f80
  v_cmp_eq_u32 vcc, 0, v29
  v_mov_b32 v30, 21760
  s_nop 0
  v_cndmask_b32 v247, v247, v30, vcc
  s_mov_b32 s64, -1
  s_mov_b32 s65, 0
  v_and_b32 v26, 1, v1
  v_cmp_eq_u32 vcc, 1, v26
  s_nop 1
  v_cndmask_b32 v160, 0, v176, vcc
  v_and_b32 v26, 16, v1
  v_cmp_eq_u32 vcc, 0, v26
  v_mov_b32 v26, 0x7f000000
  s_nop 0
  v_cndmask_b32 v165, v26, v23, vcc
  v_bfe_u32 v26, v1, 3, 1
  v_bfe_u32 v28, v1, 1, 1
  v_lshl_add_u32 v26, v26, 1, v28
  v_lshl_add_u32 v26, v27, 2, v26
  v_and_b32 v28, 5, v1
  v_bfe_u32 v29, v1, 4, 1
  v_lshl_add_u32 v28, v29, 1, v28
  v_lshl_add_u32 v26, v26, 3, v28
  s_lshl_b32 s35, s28, 10
  v_lshl_add_u32 v166, v26, 4, s35
  s_cmp_ge_u32 s29, 0
  s_cselect_b32 s35, 0x3f803f80, 0
  v_mov_b32 v26, s35
  v_accvgpr_write_b32 a161, v26
  v_accvgpr_write_b32 a163, v26
  v_accvgpr_write_b32 a165, v26
  v_accvgpr_write_b32 a167, v26
  s_cmp_ge_u32 s29, 1
  s_cselect_b32 s35, 0x3f803f80, 0
  v_mov_b32 v26, s35
  v_accvgpr_write_b32 a217, v26
  v_accvgpr_write_b32 a219, v26
  v_accvgpr_write_b32 a221, v26
  v_accvgpr_write_b32 a223, v26
  s_cmp_ge_u32 s29, 2
  s_cselect_b32 s35, 0x3f803f80, 0
  v_mov_b32 v26, s35
  v_accvgpr_write_b32 a241, v26
  v_accvgpr_write_b32 a243, v26
  v_accvgpr_write_b32 a245, v26
  v_accvgpr_write_b32 a247, v26
  s_lshl_b32 s35, s28, 12
  v_add_u32 v19, s35, v22
  s_lshr_b32 s38, s28, 1
  s_lshl_b32 s39, s38, 9
  s_and_b32 s38, s28, 1
  s_lshl_b32 s38, s38, 2
  s_add_u32 s39, s39, s38
  s_add_u32 s39, s39, 16384
  v_bfe_u32 v26, v1, 4, 1
  v_and_b32 v28, 7, v1
  v_lshl_add_u32 v26, v26, 3, v28
  v_lshlrev_b32 v26, 4, v26
  v_and_b32 v28, 8, v1
  v_add3_u32 v20, v26, v28, s39
  v_and_b32 v26, 15, v1
  v_lshl_add_u32 v28, v26, 4, s35
  v_lshl_add_u32 v28, v27, 8, v28
  v_and_b32 v29, 11, v26
  v_cmp_eq_u32 vcc, 8, v29
  s_nop 1
  v_cndmask_b32 v29, 4, 5, vcc
  v_cmp_gt_u32 vcc, 2, v26
  v_lshl_add_u32 v26, v27, 1, v26
  s_nop 0
  v_cndmask_b32 v26, v29, v26, vcc
  s_lshl_b32 s38, s28, 7
  s_add_u32 s38, s38, 16384
  v_lshl_add_u32 v26, v26, 4, s38
  v_and_b32 v29, 16, v1
  v_cmp_eq_u32 vcc, 0, v29
  s_nop 1
  v_cndmask_b32 v21, v26, v28, vcc
  v_add_u32 v21, 20480, v21
  v_bfe_u32 v26, v1, 4, 1
  v_mul_u32_u24 v30, 36864, v26
  v_lshl_add_u32 v26, v27, 8, v30
  v_and_b32 v28, 15, v1
  v_lshl_add_u32 v24, v28, 4, v26
  v_lshlrev_b32 v254, 3, v28
  v_lshlrev_b32 v28, 2, v28
  v_add_u32 v26, v30, v28
  v_mov_b32 v28, 0x7f000000
  v_cndmask_b32 v25, v28, v26, s[64:65]
  s_lshl_b32 s35, s29, 1
  s_add_u32 s35, s35, s30
  s_lshl_b32 s35, s35, 3
  s_add_u32 s35, s35, s31
  s_mul_i32 s54, s35, 40960
  s_add_u32 s54, s54, 1048576
  s_lshl_b32 s35, s35, 2
  s_add_u32 s53, s35, s28
  s_lshl_b32 s63, s53, 3
  s_add_u32 s63, s63, 4096
  s_cmp_ge_u32 s29, 1
  s_cselect_b32 s35, 655360, 0
  s_sub_u32 s57, s54, s35
  s_cmp_ge_u32 s29, 2
  s_cselect_b32 s35, 1310720, 0
  s_sub_u32 s58, s54, s35
  s_add_u32 s40, s40, s57
  s_addc_u32 s41, s41, 0
  s_lshl_b32 s35, s30, 3
  s_add_u32 s35, s35, s31
  s_lshl_b32 s35, s35, 2
  s_add_u32 s35, s35, s28
  s_mul_i32 s38, s29, 294912
  s_add_u32 s38, s38, 13631488
  s_lshl_b32 s68, s35, 9
  s_add_u32 s68, s68, s38
  s_lshl_b32 s69, s35, 6
  s_add_u32 s69, s69, s38
  s_add_u32 s69, s69, 32768
  s_cmp_ge_u32 s29, 1
  s_cselect_b32 s80, 512, 0
  s_cmp_ge_u32 s29, 2
  s_cselect_b32 s81, 1024, 0
  s_and_b32 s35, s63, 0xffffffe0
  s_sub_u32 s80, s35, s80
  s_sub_u32 s81, s35, s81
  v_mov_b32 v26, s80
  v_mov_b32 v27, s81
  v_cndmask_b32 v238, v27, v26, s[64:65]
  v_and_b32 v26, 3, v1
  v_lshl_add_u32 v238, v26, 3, v238
  v_add_u32 v239, 131072, v238
  v_and_b32 v26, 31, v1
  v_lshrrev_b32 v27, 5, v1
  v_lshlrev_b32 v27, 2, v27
  v_sub_u32 v246, v26, v27
  s_mov_b32 s80, 0xff800000
  v_subrev_u32 v27, 0, v246
  v_ashrrev_i32 v27, 31, v27
  v_and_b32 v200, s80, v27
  v_xor_b32 v184, s80, v200
  v_subrev_u32 v27, 1, v246
  v_ashrrev_i32 v27, 31, v27
  v_and_b32 v201, s80, v27
  v_xor_b32 v185, s80, v201
  v_subrev_u32 v27, 2, v246
  v_ashrrev_i32 v27, 31, v27
  v_and_b32 v202, s80, v27
  v_xor_b32 v186, s80, v202
  v_subrev_u32 v27, 3, v246
  v_ashrrev_i32 v27, 31, v27
  v_and_b32 v203, s80, v27
  v_xor_b32 v187, s80, v203
  v_subrev_u32 v27, 8, v246
  v_ashrrev_i32 v27, 31, v27
  v_and_b32 v204, s80, v27
  v_xor_b32 v188, s80, v204
  v_subrev_u32 v27, 9, v246
  v_ashrrev_i32 v27, 31, v27
  v_and_b32 v205, s80, v27
  v_xor_b32 v189, s80, v205
  v_subrev_u32 v27, 10, v246
  v_ashrrev_i32 v27, 31, v27
  v_and_b32 v206, s80, v27
  v_xor_b32 v190, s80, v206
  v_subrev_u32 v27, 11, v246
  v_ashrrev_i32 v27, 31, v27
  v_and_b32 v207, s80, v27
  v_xor_b32 v191, s80, v207
  v_subrev_u32 v27, 16, v246
  v_ashrrev_i32 v27, 31, v27
  v_and_b32 v208, s80, v27
  v_xor_b32 v192, s80, v208
  v_subrev_u32 v27, 17, v246
  v_ashrrev_i32 v27, 31, v27
  v_and_b32 v209, s80, v27
  v_xor_b32 v193, s80, v209
  v_subrev_u32 v27, 18, v246
  v_ashrrev_i32 v27, 31, v27
  v_and_b32 v210, s80, v27
  v_xor_b32 v194, s80, v210
  v_subrev_u32 v27, 19, v246
  v_ashrrev_i32 v27, 31, v27
  v_and_b32 v211, s80, v27
  v_xor_b32 v195, s80, v211
  v_subrev_u32 v27, 24, v246
  v_ashrrev_i32 v27, 31, v27
  v_and_b32 v212, s80, v27
  v_xor_b32 v196, s80, v212
  v_subrev_u32 v27, 25, v246
  v_ashrrev_i32 v27, 31, v27
  v_and_b32 v213, s80, v27
  v_xor_b32 v197, s80, v213
  v_subrev_u32 v27, 26, v246
  v_ashrrev_i32 v27, 31, v27
  v_and_b32 v214, s80, v27
  v_xor_b32 v198, s80, v214
  v_subrev_u32 v27, 27, v246
  v_ashrrev_i32 v27, 31, v27
  v_and_b32 v215, s80, v27
  v_xor_b32 v199, s80, v215
  s_mov_b32 s90, 0x3eae1a93
  s_mov_b32 s82, 0xf0f0f0f0
  s_mov_b32 s83, 0xf0f0f0f0
  s_and_b32 s35, s2, 3
  s_lshl_b32 s35, s35, 5
  s_lshr_b32 s38, s2, 3
  s_add_u32 s70, s35, s38
  s_mul_i32 s71, s70, 7282
  s_lshr_b32 s71, s71, 16
  s_mul_i32 s35, s71, 9
  s_sub_u32 s72, s70, s35
  s_min_u32 s71, s71, 13
  s_and_b32 s39, s2, 4
  s_xor_b32 s39, s39, 4
  s_lshl_b32 s39, s39, 4
  s_lshr_b32 s35, s71, 1
  s_add_u32 s35, s35, 1
  s_lshl_b32 s35, s35, 3
  s_and_b32 s38, s71, 1
  s_add_u32 s35, s35, s38
  s_add_u32 s35, s35, s39
  s_add_u32 s39, s39, s71
  s_sub_u32 s38, s35, 26
  s_cmp_lt_u32 s71, 8
  s_cselect_b32 s38, s39, s38
  s_cmp_lt_u32 s71, 12
  s_cselect_b32 s94, 36864, 0
  s_cselect_b32 s98, 2359296, 0
  s_cselect_b32 s38, s38, s35
  s_lshr_b32 s84, s35, 3
  s_lshl_b32 s84, s84, 2
  s_add_u32 s84, s84, s28
  s_lshl_b32 s84, s84, 7
  s_add_u32 s84, s84, 266240
  s_mul_i32 s85, s35, 36864
  s_add_u32 s85, s85, 13631488
  s_add_u32 s85, s85, s12
  s_addc_u32 s86, s13, 0
  s_mul_i32 s87, s35, 18432
  s_lshl_b32 s48, s72, 7
  s_add_u32 s87, s87, s48
  s_lshr_b32 s88, s38, 3
  s_lshl_b32 s88, s88, 2
  s_add_u32 s88, s88, s28
  s_lshl_b32 s88, s88, 7
  s_add_u32 s88, s88, 266240
  s_mul_i32 s59, s38, 36864
  s_add_u32 s59, s59, 13631488
  s_add_u32 s59, s59, s12
  s_addc_u32 s62, s13, 0
  s_mul_i32 s91, s38, 18432
  s_lshl_b32 s48, s72, 7
  s_add_u32 s91, s91, s48
  s_mov_b32 s92, s59
  s_mov_b32 s93, s62
  s_mov_b32 s95, 0x20000
  s_mov_b32 s96, s20
  s_mov_b32 s97, s21
  s_mov_b32 s99, 0x20000
  v_lshrrev_b32 v26, 3, v1
  v_and_b32 v27, 7, v1
  v_and_b32 v28, 6, v26
  v_xor_b32 v27, v27, v28
  v_mul_u32_u24 v26, 1152, v26
  v_lshl_add_u32 v253, v27, 4, v26
  v_add_u32 v177, 8192, v253
  v_add_u32 v178, 16384, v253
  v_add_u32 v179, 24576, v253
  s_lshl_b32 s38, s2, 1
  s_and_b32 s35, s28, 1
  s_add_u32 s38, s38, s35
  s_mul_i32 s38, s38, 1408
  v_lshrrev_b32 v162, 2, v1
  v_min_u32 v162, 10, v162
  v_lshl_add_u32 v162, v162, 7, s38
  v_and_b32 v163, 31, v1
  v_lshlrev_b32 v163, 2, v163
  s_mov_b32 s25, 0x5f800000
  s_cmp_eq_u32 s30, 0
  s_cselect_b64 s[66:67], -1, 0
  v_lshrrev_b32 v164, 4, v1
  v_add_u32 v164, 1, v164
  v_lshlrev_b32 v164, 17, v164
  s_mov_b64 exec, 0
  s_cmp_eq_u32 s28, 0
  s_cbranch_scc1 L_pad_0
  s_cmp_eq_u32 s28, 1
  s_cbranch_scc1 L_pad_1
  s_cmp_eq_u32 s28, 2
  s_cbranch_scc1 L_pad_2
  s_branch L_pad_3
L_pad_ret:
  s_mov_b64 exec, -1
  s_mul_i32 s79, s32, 1728
  s_add_u32 s60, s6, s79
  s_addc_u32 s61, s7, 0
  s_add_u32 m0, s52, 9216
  s_nop 0
  global_load_lds_dwordx4 v6, s[60:61] offset:0
  global_load_lds_dwordx4 v7, s[60:61] offset:1008
  s_mov_b64 exec, 0x3ffff
  global_load_lds_dwordx4 v8, s[60:61] offset:2016
  s_mov_b64 exec, -1
  s_add_u32 s60, s4, s33
  s_addc_u32 s61, s5, 0
  s_add_u32 m0, s51, 8192
  s_nop 0
  global_load_lds_dwordx4 v2, s[60:61] offset:0
  global_load_lds_dwordx4 v3, s[60:61] offset:1024
  global_load_lds_dwordx4 v4, s[60:61] offset:2048
  global_load_lds_dwordx4 v5, s[60:61] offset:3072
  v_add_u32 v13, s34, v241
  s_waitcnt vmcnt(11)
  s_barrier
  ds_read_b128 a[0:3], v9 offset:0
  ds_read_b128 a[4:7], v9 offset:1024
  ds_read_b64_tr_b16 v[136:137], v17 offset:0
  ds_read_b64_tr_b16 v[138:139], v17 offset:2304
  s_mov_b64 exec, s[82:83]
  ds_read_b128 v[136:139], v13 offset:0
  s_mov_b64 exec, -1
  ds_read_b64_tr_b16 v[120:121], v11 offset:0
  ds_read_b64_tr_b16 v[122:123], v11 offset:2304
  ds_read_b64_tr_b16 v[124:125], v11 offset:8
  ds_read_b64_tr_b16 v[126:127], v11 offset:2312
  ds_read_b64_tr_b16 v[128:129], v11 offset:72
  ds_read_b64_tr_b16 v[130:131], v11 offset:2376
  ds_read_b64_tr_b16 v[132:133], v11 offset:80
  ds_read_b64_tr_b16 v[134:135], v11 offset:2384
  s_waitcnt lgkmcnt(8)
  v_mfma_f32_16x16x32_bf16 v[48:51], v[136:139], a[0:3], 0
  s_mul_i32 s79, s33, 1728
  ds_read_b128 a[8:11], v10 offset:0
  ds_read_b128 a[12:15], v10 offset:1024
  v_mfma_f32_16x16x32_bf16 v[68:71], v[136:139], a[4:7], 0
  s_add_u32 s60, s6, s79
  ds_read_b64_tr_b16 v[156:157], v17 offset:4608
  s_waitcnt lgkmcnt(9)
  v_mfma_f32_16x16x32_bf16 v[32:35], v[120:123], a[0:3], 0
  s_addc_u32 s61, s7, 0
  ds_read_b64_tr_b16 v[158:159], v17 offset:6912
  v_mfma_f32_16x16x32_bf16 v[52:55], v[120:123], a[4:7], 0
  s_add_u32 m0, s52, 18432
  s_mov_b64 exec, s[82:83]
  ds_read_b128 v[156:159], v13 offset:64
  s_mov_b64 exec, -1
  ds_read_b64_tr_b16 v[140:141], v11 offset:4608
  global_load_lds_dwordx4 v6, s[60:61] offset:0
  s_waitcnt lgkmcnt(10)
  v_mfma_f32_16x16x32_bf16 v[36:39], v[124:127], a[0:3], 0
  ds_read_b64_tr_b16 v[142:143], v11 offset:6912
  v_mfma_f32_16x16x32_bf16 v[56:59], v[124:127], a[4:7], 0
  s_waitcnt lgkmcnt(9)
  ds_read_b64_tr_b16 v[144:145], v11 offset:4616
  global_load_lds_dwordx4 v7, s[60:61] offset:1008
  v_mfma_f32_16x16x32_bf16 v[40:43], v[128:131], a[0:3], 0
  ds_read_b64_tr_b16 v[146:147], v11 offset:6920
  ds_read_b64_tr_b16 v[148:149], v11 offset:4680
  v_mfma_f32_16x16x32_bf16 v[60:63], v[128:131], a[4:7], 0
  ds_read_b64_tr_b16 v[150:151], v11 offset:6984
  s_mov_b64 exec, 0x3ffff
  global_load_lds_dwordx4 v8, s[60:61] offset:2016
  s_mov_b64 exec, -1
  s_waitcnt lgkmcnt(11)
  v_mfma_f32_16x16x32_bf16 v[44:47], v[132:135], a[0:3], 0
  ds_read_b64_tr_b16 v[152:153], v11 offset:4688
  v_mfma_f32_16x16x32_bf16 v[64:67], v[132:135], a[4:7], 0
  ds_read_b64_tr_b16 v[154:155], v11 offset:6992
  v_add_u32 v13, s32, v241
  s_waitcnt vmcnt(7) lgkmcnt(8)
  v_mfma_f32_16x16x32_bf16 v[48:51], v[156:159], a[8:11], v[48:51]
  s_barrier
  ds_read_b128 a[16:19], v9 offset:4096
  v_mfma_f32_16x16x32_bf16 v[68:71], v[156:159], a[12:15], v[68:71]
  s_add_u32 s60, s4, s36
  ds_read_b128 a[20:23], v9 offset:5120
  ds_read_b64_tr_b16 v[136:137], v17 offset:9216
  s_waitcnt lgkmcnt(9)
L_pad_0:
  s_cbranch_execz L_pad_4
  v_mfma_f32_16x16x32_bf16 v[32:35], v[140:143], a[8:11], v[32:35]
  s_addc_u32 s61, s5, 0
  ds_read_b64_tr_b16 v[138:139], v17 offset:11520
  v_mfma_f32_16x16x32_bf16 v[52:55], v[140:143], a[12:15], v[52:55]
  s_add_u32 m0, s51, 0
  s_mov_b64 exec, s[82:83]
  ds_read_b128 v[136:139], v13 offset:0
  s_mov_b64 exec, -1
  global_load_lds_dwordx4 v2, s[60:61] offset:0
  s_waitcnt lgkmcnt(9)
  v_mfma_f32_16x16x32_bf16 v[36:39], v[144:147], a[8:11], v[36:39]
  ds_read_b64_tr_b16 v[120:121], v11 offset:9216
  ds_read_b64_tr_b16 v[122:123], v11 offset:11520
  v_mfma_f32_16x16x32_bf16 v[56:59], v[144:147], a[12:15], v[56:59]
  s_waitcnt lgkmcnt(9)
  ds_read_b64_tr_b16 v[124:125], v11 offset:9224
  global_load_lds_dwordx4 v3, s[60:61] offset:1024
  v_mfma_f32_16x16x32_bf16 v[40:43], v[148:151], a[8:11], v[40:43]
  ds_read_b64_tr_b16 v[126:127], v11 offset:11528
  v_mfma_f32_16x16x32_bf16 v[60:63], v[148:151], a[12:15], v[60:63]
  s_waitcnt lgkmcnt(9)
  ds_read_b64_tr_b16 v[128:129], v11 offset:9288
  ds_read_b64_tr_b16 v[130:131], v11 offset:11592
  global_load_lds_dwordx4 v4, s[60:61] offset:2048
  v_mfma_f32_16x16x32_bf16 v[44:47], v[152:155], a[8:11], v[44:47]
  ds_read_b64_tr_b16 v[132:133], v11 offset:9296
  v_mfma_f32_16x16x32_bf16 v[64:67], v[152:155], a[12:15], v[64:67]
  s_waitcnt lgkmcnt(7)
  ds_read_b64_tr_b16 v[134:135], v11 offset:11600
  global_load_lds_dwordx4 v5, s[60:61] offset:3072
  v_mfma_f32_16x16x32_bf16 v[48:51], v[136:139], a[16:19], v[48:51]
  s_mul_i32 s79, s36, 1728
  ds_read_b128 a[24:27], v10 offset:4096
  ds_read_b128 a[28:31], v10 offset:5120
  v_mfma_f32_16x16x32_bf16 v[68:71], v[136:139], a[20:23], v[68:71]
  s_add_u32 s60, s6, s79
  ds_read_b64_tr_b16 v[156:157], v17 offset:13824
  s_waitcnt lgkmcnt(9)
  v_mfma_f32_16x16x32_bf16 v[32:35], v[120:123], a[16:19], v[32:35]
  s_addc_u32 s61, s7, 0
  ds_read_b64_tr_b16 v[158:159], v17 offset:16128
  v_mfma_f32_16x16x32_bf16 v[52:55], v[120:123], a[20:23], v[52:55]
  s_add_u32 m0, s52, 27648
  s_mov_b64 exec, s[82:83]
  ds_read_b128 v[156:159], v13 offset:64
  s_mov_b64 exec, -1
  ds_read_b64_tr_b16 v[140:141], v11 offset:13824
  global_load_lds_dwordx4 v6, s[60:61] offset:0
  s_waitcnt lgkmcnt(10)
  v_mfma_f32_16x16x32_bf16 v[36:39], v[124:127], a[16:19], v[36:39]
  ds_read_b64_tr_b16 v[142:143], v11 offset:16128
  v_mfma_f32_16x16x32_bf16 v[56:59], v[124:127], a[20:23], v[56:59]
  s_waitcnt lgkmcnt(9)
  ds_read_b64_tr_b16 v[144:145], v11 offset:13832
  global_load_lds_dwordx4 v7, s[60:61] offset:1008
  v_mfma_f32_16x16x32_bf16 v[40:43], v[128:131], a[16:19], v[40:43]
  ds_read_b64_tr_b16 v[146:147], v11 offset:16136
  ds_read_b64_tr_b16 v[148:149], v11 offset:13896
  v_mfma_f32_16x16x32_bf16 v[60:63], v[128:131], a[20:23], v[60:63]
  ds_read_b64_tr_b16 v[150:151], v11 offset:16200
  s_mov_b64 exec, 0x3ffff
  global_load_lds_dwordx4 v8, s[60:61] offset:2016
  s_mov_b64 exec, -1
  s_waitcnt lgkmcnt(11)
  v_mfma_f32_16x16x32_bf16 v[44:47], v[132:135], a[16:19], v[44:47]
  ds_read_b64_tr_b16 v[152:153], v11 offset:13904
  v_mfma_f32_16x16x32_bf16 v[64:67], v[132:135], a[20:23], v[64:67]
  ds_read_b64_tr_b16 v[154:155], v11 offset:16208
  v_add_u32 v13, s33, v241
  s_waitcnt vmcnt(7) lgkmcnt(8)
  v_mfma_f32_16x16x32_bf16 v[48:51], v[156:159], a[24:27], v[48:51]
  s_barrier
  ds_read_b128 a[32:35], v9 offset:8192
  v_mfma_f32_16x16x32_bf16 v[68:71], v[156:159], a[28:31], v[68:71]
  s_add_u32 s60, s4, s37
  ds_read_b128 a[36:39], v9 offset:9216
  ds_read_b64_tr_b16 v[136:137], v17 offset:18432
  s_waitcnt lgkmcnt(9)
  v_mfma_f32_16x16x32_bf16 v[32:35], v[140:143], a[24:27], v[32:35]
  s_addc_u32 s61, s5, 0
  ds_read_b64_tr_b16 v[138:139], v17 offset:20736
  v_mfma_f32_16x16x32_bf16 v[52:55], v[140:143], a[28:31], v[52:55]
  s_add_u32 m0, s51, 4096
  s_mov_b64 exec, s[82:83]
  ds_read_b128 v[136:139], v13 offset:0
  s_mov_b64 exec, -1
  global_load_lds_dwordx4 v2, s[60:61] offset:0
  s_waitcnt lgkmcnt(9)
  v_mfma_f32_16x16x32_bf16 v[36:39], v[144:147], a[24:27], v[36:39]
  ds_read_b64_tr_b16 v[120:121], v11 offset:18432
  ds_read_b64_tr_b16 v[122:123], v11 offset:20736
  v_mfma_f32_16x16x32_bf16 v[56:59], v[144:147], a[28:31], v[56:59]
  s_waitcnt lgkmcnt(9)
  ds_read_b64_tr_b16 v[124:125], v11 offset:18440
  global_load_lds_dwordx4 v3, s[60:61] offset:1024
  v_mfma_f32_16x16x32_bf16 v[40:43], v[148:151], a[24:27], v[40:43]
  ds_read_b64_tr_b16 v[126:127], v11 offset:20744
  v_mfma_f32_16x16x32_bf16 v[60:63], v[148:151], a[28:31], v[60:63]
  s_waitcnt lgkmcnt(9)
  ds_read_b64_tr_b16 v[128:129], v11 offset:18504
  ds_read_b64_tr_b16 v[130:131], v11 offset:20808
  global_load_lds_dwordx4 v4, s[60:61] offset:2048
  v_mfma_f32_16x16x32_bf16 v[44:47], v[152:155], a[24:27], v[44:47]
  ds_read_b64_tr_b16 v[132:133], v11 offset:18512
  v_mfma_f32_16x16x32_bf16 v[64:67], v[152:155], a[28:31], v[64:67]
  s_waitcnt lgkmcnt(7)
  ds_read_b64_tr_b16 v[134:135], v11 offset:20816
  global_load_lds_dwordx4 v5, s[60:61] offset:3072
  v_mfma_f32_16x16x32_bf16 v[48:51], v[136:139], a[32:35], v[48:51]
  s_mul_i32 s79, s37, 1728
  ds_read_b128 a[40:43], v10 offset:8192
  ds_read_b128 a[44:47], v10 offset:9216
  v_mfma_f32_16x16x32_bf16 v[68:71], v[136:139], a[36:39], v[68:71]
  s_add_u32 s60, s6, s79
  ds_read_b64_tr_b16 v[156:157], v17 offset:23040
  s_waitcnt lgkmcnt(9)
  v_mfma_f32_16x16x32_bf16 v[32:35], v[120:123], a[32:35], v[32:35]
  s_addc_u32 s61, s7, 0
  ds_read_b64_tr_b16 v[158:159], v17 offset:25344
  v_mfma_f32_16x16x32_bf16 v[52:55], v[120:123], a[36:39], v[52:55]
  s_add_u32 m0, s52, 0
  s_mov_b64 exec, s[82:83]
  ds_read_b128 v[156:159], v13 offset:64
  s_mov_b64 exec, -1
  ds_read_b64_tr_b16 v[140:141], v11 offset:23040
  global_load_lds_dwordx4 v6, s[60:61] offset:0
  s_waitcnt lgkmcnt(10)
  v_mfma_f32_16x16x32_bf16 v[36:39], v[124:127], a[32:35], v[36:39]
  ds_read_b64_tr_b16 v[142:143], v11 offset:25344
  v_mfma_f32_16x16x32_bf16 v[56:59], v[124:127], a[36:39], v[56:59]
  s_waitcnt lgkmcnt(9)
  ds_read_b64_tr_b16 v[144:145], v11 offset:23048
  global_load_lds_dwordx4 v7, s[60:61] offset:1008
  v_mfma_f32_16x16x32_bf16 v[40:43], v[128:131], a[32:35], v[40:43]
  ds_read_b64_tr_b16 v[146:147], v11 offset:25352
  ds_read_b64_tr_b16 v[148:149], v11 offset:23112
  v_mfma_f32_16x16x32_bf16 v[60:63], v[128:131], a[36:39], v[60:63]
  ds_read_b64_tr_b16 v[150:151], v11 offset:25416
  s_mov_b64 exec, 0x3ffff
  global_load_lds_dwordx4 v8, s[60:61] offset:2016
  s_mov_b64 exec, -1
  s_waitcnt lgkmcnt(11)
  v_mfma_f32_16x16x32_bf16 v[44:47], v[132:135], a[32:35], v[44:47]
  ds_read_b64_tr_b16 v[152:153], v11 offset:23120
  v_mfma_f32_16x16x32_bf16 v[64:67], v[132:135], a[36:39], v[64:67]
  ds_read_b64_tr_b16 v[154:155], v11 offset:25424
  v_add_u32 v13, s36, v241
  s_waitcnt vmcnt(7) lgkmcnt(8)
  v_mfma_f32_16x16x32_bf16 v[48:51], v[156:159], a[40:43], v[48:51]
  s_barrier
  ds_read_b128 a[48:51], v9 offset:0
  v_mfma_f32_16x16x32_bf16 v[68:71], v[156:159], a[44:47], v[68:71]
  s_add_u32 s60, s4, s49
  ds_read_b128 a[52:55], v9 offset:1024
  ds_read_b64_tr_b16 v[136:137], v17 offset:27648
  s_waitcnt lgkmcnt(9)
  v_mfma_f32_16x16x32_bf16 v[32:35], v[140:143], a[40:43], v[32:35]
  s_addc_u32 s61, s5, 0
  ds_read_b64_tr_b16 v[138:139], v17 offset:29952
  v_mfma_f32_16x16x32_bf16 v[52:55], v[140:143], a[44:47], v[52:55]
  s_add_u32 m0, s51, 8192
  s_mov_b64 exec, s[82:83]
  ds_read_b128 v[136:139], v13 offset:0
  s_mov_b64 exec, -1
  global_load_lds_dwordx4 v2, s[60:61] offset:0
  s_waitcnt lgkmcnt(9)
  v_mfma_f32_16x16x32_bf16 v[36:39], v[144:147], a[40:43], v[36:39]
  ds_read_b64_tr_b16 v[120:121], v11 offset:27648
  ds_read_b64_tr_b16 v[122:123], v11 offset:29952
  v_mfma_f32_16x16x32_bf16 v[56:59], v[144:147], a[44:47], v[56:59]
  s_waitcnt lgkmcnt(9)
  ds_read_b64_tr_b16 v[124:125], v11 offset:27656
  global_load_lds_dwordx4 v3, s[60:61] offset:1024
  v_mfma_f32_16x16x32_bf16 v[40:43], v[148:151], a[40:43], v[40:43]
  ds_read_b64_tr_b16 v[126:127], v11 offset:29960
  v_mfma_f32_16x16x32_bf16 v[60:63], v[148:151], a[44:47], v[60:63]
  s_waitcnt lgkmcnt(9)
  ds_read_b64_tr_b16 v[128:129], v11 offset:27720
  ds_read_b64_tr_b16 v[130:131], v11 offset:30024
  global_load_lds_dwordx4 v4, s[60:61] offset:2048
  v_mfma_f32_16x16x32_bf16 v[44:47], v[152:155], a[40:43], v[44:47]
  ds_read_b64_tr_b16 v[132:133], v11 offset:27728
  v_mfma_f32_16x16x32_bf16 v[64:67], v[152:155], a[44:47], v[64:67]
  s_waitcnt lgkmcnt(7)
  ds_read_b64_tr_b16 v[134:135], v11 offset:30032
  global_load_lds_dwordx4 v5, s[60:61] offset:3072
  v_mfma_f32_16x16x32_bf16 v[48:51], v[136:139], a[48:51], v[48:51]
  s_mul_i32 s79, s49, 1728
  ds_read_b128 a[56:59], v10 offset:0
  ds_read_b128 a[60:63], v10 offset:1024
  v_mfma_f32_16x16x32_bf16 v[68:71], v[136:139], a[52:55], v[68:71]
  s_add_u32 s60, s6, s79
  ds_read_b64_tr_b16 v[156:157], v17 offset:32256
  s_waitcnt lgkmcnt(9)
  v_mfma_f32_16x16x32_bf16 v[32:35], v[120:123], a[48:51], v[32:35]
  s_addc_u32 s61, s7, 0
  ds_read_b64_tr_b16 v[158:159], v17 offset:34560
  v_mfma_f32_16x16x32_bf16 v[52:55], v[120:123], a[52:55], v[52:55]
  s_add_u32 m0, s52, 9216
  s_mov_b64 exec, s[82:83]
  ds_read_b128 v[156:159], v13 offset:64
  s_mov_b64 exec, -1
  ds_read_b64_tr_b16 v[140:141], v11 offset:32256
  global_load_lds_dwordx4 v6, s[60:61] offset:0
  s_waitcnt lgkmcnt(10)
  v_mfma_f32_16x16x32_bf16 v[36:39], v[124:127], a[48:51], v[36:39]
  ds_read_b64_tr_b16 v[142:143], v11 offset:34560
  v_mfma_f32_16x16x32_bf16 v[56:59], v[124:127], a[52:55], v[56:59]
  s_waitcnt lgkmcnt(9)
  ds_read_b64_tr_b16 v[144:145], v11 offset:32264
  global_load_lds_dwordx4 v7, s[60:61] offset:1008
  v_mfma_f32_16x16x32_bf16 v[40:43], v[128:131], a[48:51], v[40:43]
  ds_read_b64_tr_b16 v[146:147], v11 offset:34568
  ds_read_b64_tr_b16 v[148:149], v11 offset:32328
  v_mfma_f32_16x16x32_bf16 v[60:63], v[128:131], a[52:55], v[60:63]
  ds_read_b64_tr_b16 v[150:151], v11 offset:34632
  s_mov_b64 exec, 0x3ffff
  global_load_lds_dwordx4 v8, s[60:61] offset:2016
  s_mov_b64 exec, -1
  s_waitcnt lgkmcnt(11)
  v_mfma_f32_16x16x32_bf16 v[44:47], v[132:135], a[48:51], v[44:47]
  ds_read_b64_tr_b16 v[152:153], v11 offset:32336
  v_mfma_f32_16x16x32_bf16 v[64:67], v[132:135], a[52:55], v[64:67]
  ds_read_b64_tr_b16 v[154:155], v11 offset:34640
  v_add_u32 v13, s37, v241
  s_waitcnt vmcnt(7) lgkmcnt(8)
  v_mfma_f32_16x16x32_bf16 v[48:51], v[156:159], a[56:59], v[48:51]
  s_barrier
  ds_read_b128 a[64:67], v9 offset:4096
  v_mfma_f32_16x16x32_bf16 v[68:71], v[156:159], a[60:63], v[68:71]
  s_mul_i32 s79, s34, 1728
  ds_read_b128 a[68:71], v9 offset:5120
  ds_read_b64_tr_b16 v[136:137], v17 offset:0
  s_waitcnt lgkmcnt(9)
  v_mfma_f32_16x16x32_bf16 v[32:35], v[140:143], a[56:59], v[32:35]
  s_add_u32 s60, s10, s79
  ds_read_b64_tr_b16 v[138:139], v17 offset:2304
  v_mfma_f32_16x16x32_bf16 v[52:55], v[140:143], a[60:63], v[52:55]
  s_addc_u32 s61, s11, 0
  s_mov_b64 exec, s[82:83]
  ds_read_b128 v[136:139], v13 offset:0
  s_mov_b64 exec, -1
  s_waitcnt lgkmcnt(9)
  v_mfma_f32_16x16x32_bf16 v[36:39], v[144:147], a[56:59], v[36:39]
  s_add_u32 m0, s52, 18432
  ds_read_b64_tr_b16 v[120:121], v11 offset:0
  ds_read_b64_tr_b16 v[122:123], v11 offset:2304
  global_load_lds_dwordx4 v6, s[60:61] offset:0
  v_mfma_f32_16x16x32_bf16 v[56:59], v[144:147], a[60:63], v[56:59]
  s_waitcnt lgkmcnt(9)
  ds_read_b64_tr_b16 v[124:125], v11 offset:8
  v_mfma_f32_16x16x32_bf16 v[40:43], v[148:151], a[56:59], v[40:43]
  ds_read_b64_tr_b16 v[126:127], v11 offset:2312
  global_load_lds_dwordx4 v7, s[60:61] offset:1008
  v_mfma_f32_16x16x32_bf16 v[60:63], v[148:151], a[60:63], v[60:63]
  s_waitcnt lgkmcnt(9)
  ds_read_b64_tr_b16 v[128:129], v11 offset:72
  ds_read_b64_tr_b16 v[130:131], v11 offset:2376
  v_mfma_f32_16x16x32_bf16 v[44:47], v[152:155], a[56:59], v[44:47]
  ds_read_b64_tr_b16 v[132:133], v11 offset:80
  s_mov_b64 exec, 0x3ffff
  global_load_lds_dwordx4 v8, s[60:61] offset:2016
  s_mov_b64 exec, -1
  v_mfma_f32_16x16x32_bf16 v[64:67], v[152:155], a[60:63], v[64:67]
  s_waitcnt lgkmcnt(7)
  ds_read_b64_tr_b16 v[134:135], v11 offset:2384
  v_mfma_f32_16x16x32_bf16 v[48:51], v[136:139], a[64:67], v[48:51]
  ds_read_b128 a[72:75], v10 offset:4096
  ds_read_b128 a[76:79], v10 offset:5120
  buffer_load_dwordx2 v[232:233], v240, s[12:15], 0 offen sc1
  v_mfma_f32_16x16x32_bf16 v[68:71], v[136:139], a[68:71], v[68:71]
  s_waitcnt lgkmcnt(8)
  ds_read_b64_tr_b16 v[156:157], v17 offset:4608
  v_mfma_f32_16x16x32_bf16 v[32:35], v[120:123], a[64:67], v[32:35]
  ds_read_b64_tr_b16 v[158:159], v17 offset:6912
  buffer_load_dword a252, v164, s[12:15], s63 offen sc1
  v_mfma_f32_16x16x32_bf16 v[52:55], v[120:123], a[68:71], v[52:55]
  s_add_u32 s60, s4, s50
  s_mov_b64 exec, s[82:83]
  ds_read_b128 v[156:159], v13 offset:64
  s_mov_b64 exec, -1
  ds_read_b64_tr_b16 v[140:141], v11 offset:4608
  s_waitcnt lgkmcnt(10)
  v_mfma_f32_16x16x32_bf16 v[36:39], v[124:127], a[64:67], v[36:39]
  s_addc_u32 s61, s5, 0
  ds_read_b64_tr_b16 v[142:143], v11 offset:6912
  v_mfma_f32_16x16x32_bf16 v[56:59], v[124:127], a[68:71], v[56:59]
  s_add_u32 m0, s51, 0
  ds_read_b64_tr_b16 v[144:145], v11 offset:4616
  global_load_lds_dwordx4 v2, s[60:61] offset:0
  s_waitcnt lgkmcnt(10)
  v_mfma_f32_16x16x32_bf16 v[40:43], v[128:131], a[64:67], v[40:43]
  ds_read_b64_tr_b16 v[146:147], v11 offset:6920
  ds_read_b64_tr_b16 v[148:149], v11 offset:4680
  v_mfma_f32_16x16x32_bf16 v[60:63], v[128:131], a[68:71], v[60:63]
  s_waitcnt lgkmcnt(10)
  ds_read_b64_tr_b16 v[150:151], v11 offset:6984
  global_load_lds_dwordx4 v3, s[60:61] offset:1024
  v_mfma_f32_16x16x32_bf16 v[44:47], v[132:135], a[64:67], v[44:47]
  ds_read_b64_tr_b16 v[152:153], v11 offset:4688
  v_mfma_f32_16x16x32_bf16 v[64:67], v[132:135], a[68:71], v[64:67]
  ds_read_b64_tr_b16 v[154:155], v11 offset:6992
  global_load_lds_dwordx4 v4, s[60:61] offset:2048
  global_load_lds_dwordx4 v5, s[60:61] offset:3072
  v_add_u32 v13, s49, v241
  s_waitcnt vmcnt(9) lgkmcnt(8)
  v_mfma_f32_16x16x32_bf16 v[48:51], v[156:159], a[72:75], v[48:51]
  s_barrier
  ds_read_b128 a[80:83], v9 offset:8192
  v_mfma_f32_16x16x32_bf16 v[68:71], v[156:159], a[76:79], v[68:71]
  s_mul_i32 s79, s50, 1728
  ds_read_b128 a[84:87], v9 offset:9216
  ds_read_b64_tr_b16 v[136:137], v17 offset:9216
  s_waitcnt lgkmcnt(9)
  v_mfma_f32_16x16x32_bf16 v[32:35], v[140:143], a[72:75], v[32:35]
  s_add_u32 s60, s6, s79
  ds_read_b64_tr_b16 v[138:139], v17 offset:11520
  v_mfma_f32_16x16x32_bf16 v[52:55], v[140:143], a[76:79], v[52:55]
  s_addc_u32 s61, s7, 0
  s_mov_b64 exec, s[82:83]
  ds_read_b128 v[136:139], v13 offset:0
  s_mov_b64 exec, -1
  s_waitcnt lgkmcnt(9)
  v_mfma_f32_16x16x32_bf16 v[36:39], v[144:147], a[72:75], v[36:39]
  s_add_u32 m0, s52, 27648
  ds_read_b64_tr_b16 v[120:121], v11 offset:9216
  ds_read_b64_tr_b16 v[122:123], v11 offset:11520
  global_load_lds_dwordx4 v6, s[60:61] offset:0
  v_mfma_f32_16x16x32_bf16 v[56:59], v[144:147], a[76:79], v[56:59]
  s_waitcnt lgkmcnt(9)
  ds_read_b64_tr_b16 v[124:125], v11 offset:9224
  v_mfma_f32_16x16x32_bf16 v[40:43], v[148:151], a[72:75], v[40:43]
  ds_read_b64_tr_b16 v[126:127], v11 offset:11528
  global_load_lds_dwordx4 v7, s[60:61] offset:1008
  v_mfma_f32_16x16x32_bf16 v[60:63], v[148:151], a[76:79], v[60:63]
  s_waitcnt lgkmcnt(9)
  ds_read_b64_tr_b16 v[128:129], v11 offset:9288
  ds_read_b64_tr_b16 v[130:131], v11 offset:11592
  v_mfma_f32_16x16x32_bf16 v[44:47], v[152:155], a[72:75], v[44:47]
  ds_read_b64_tr_b16 v[132:133], v11 offset:9296
  s_mov_b64 exec, 0x3ffff
  global_load_lds_dwordx4 v8, s[60:61] offset:2016
  s_mov_b64 exec, -1
  v_mfma_f32_16x16x32_bf16 v[64:67], v[152:155], a[76:79], v[64:67]
  s_mul_i32 s79, s32, 1728
  ds_read_b64_tr_b16 v[134:135], v11 offset:11600
  s_waitcnt lgkmcnt(8)
  v_mfma_f32_16x16x32_bf16 v[48:51], v[136:139], a[80:83], v[48:51]
  s_add_u32 s60, s10, s79
  ds_read_b128 a[88:91], v10 offset:8192
  ds_read_b128 a[92:95], v10 offset:9216
  v_mfma_f32_16x16x32_bf16 v[68:71], v[136:139], a[84:87], v[68:71]
  s_addc_u32 s61, s11, 0
  ds_read_b64_tr_b16 v[156:157], v17 offset:13824
  s_waitcnt lgkmcnt(9)
  v_mfma_f32_16x16x32_bf16 v[32:35], v[120:123], a[80:83], v[32:35]
  s_add_u32 m0, s52, 36864
  ds_read_b64_tr_b16 v[158:159], v17 offset:16128
  global_load_lds_dwordx4 v6, s[60:61] offset:0
  v_mfma_f32_16x16x32_bf16 v[52:55], v[120:123], a[84:87], v[52:55]
  s_mov_b64 exec, s[82:83]
  ds_read_b128 v[156:159], v13 offset:64
  s_mov_b64 exec, -1
  ds_read_b64_tr_b16 v[140:141], v11 offset:13824
  s_waitcnt lgkmcnt(10)
  v_mfma_f32_16x16x32_bf16 v[36:39], v[124:127], a[80:83], v[36:39]
  ds_read_b64_tr_b16 v[142:143], v11 offset:16128
  global_load_lds_dwordx4 v7, s[60:61] offset:1008
  v_mfma_f32_16x16x32_bf16 v[56:59], v[124:127], a[84:87], v[56:59]
  s_waitcnt lgkmcnt(9)
  ds_read_b64_tr_b16 v[144:145], v11 offset:13832
  v_mfma_f32_16x16x32_bf16 v[40:43], v[128:131], a[80:83], v[40:43]
  ds_read_b64_tr_b16 v[146:147], v11 offset:16136
  ds_read_b64_tr_b16 v[148:149], v11 offset:13896
  s_mov_b64 exec, 0x3ffff
  global_load_lds_dwordx4 v8, s[60:61] offset:2016
  s_mov_b64 exec, -1
  v_mfma_f32_16x16x32_bf16 v[60:63], v[128:131], a[84:87], v[60:63]
  s_waitcnt lgkmcnt(10)
  ds_read_b64_tr_b16 v[150:151], v11 offset:16200
  v_mfma_f32_16x16x32_bf16 v[44:47], v[132:135], a[80:83], v[44:47]
  ds_read_b64_tr_b16 v[152:153], v11 offset:13904
  v_mfma_f32_16x16x32_bf16 v[64:67], v[132:135], a[84:87], v[64:67]
  ds_read_b64_tr_b16 v[154:155], v11 offset:16208
  s_waitcnt vmcnt(12) lgkmcnt(8)
  v_mfma_f32_16x16x32_bf16 v[48:51], v[156:159], a[88:91], v[48:51]
  s_barrier
  ds_read_b64_tr_b16 v[120:121], v15 offset:18432
  v_mfma_f32_16x16x32_bf16 v[68:71], v[156:159], a[92:95], v[68:71]
  s_add_u32 s60, s4, s3
  ds_read_b64_tr_b16 v[122:123], v15 offset:20736
  s_waitcnt lgkmcnt(8)
  v_mfma_f32_16x16x32_bf16 v[32:35], v[140:143], a[88:91], v[32:35]
  s_addc_u32 s61, s5, 0
  ds_read_b64_tr_b16 v[124:125], v15 offset:18472
  v_mfma_f32_16x16x32_bf16 v[52:55], v[140:143], a[92:95], v[52:55]
  s_add_u32 m0, s51, 4096
  ds_read_b64_tr_b16 v[126:127], v15 offset:20776
  global_load_lds_dwordx4 v2, s[60:61] offset:0
  s_waitcnt lgkmcnt(8)
  v_mfma_f32_16x16x32_bf16 v[36:39], v[144:147], a[88:91], v[36:39]
  ds_read_b64_tr_b16 v[128:129], v15 offset:18504
  v_mfma_f32_16x16x32_bf16 v[56:59], v[144:147], a[92:95], v[56:59]
  s_waitcnt lgkmcnt(7)
  ds_read_b64_tr_b16 v[130:131], v15 offset:20808
  global_load_lds_dwordx4 v3, s[60:61] offset:1024
  v_mfma_f32_16x16x32_bf16 v[40:43], v[148:151], a[88:91], v[40:43]
  ds_read_b64_tr_b16 v[132:133], v15 offset:18544
  v_mfma_f32_16x16x32_bf16 v[60:63], v[148:151], a[92:95], v[60:63]
  s_waitcnt lgkmcnt(7)
  ds_read_b64_tr_b16 v[134:135], v15 offset:20848
  global_load_lds_dwordx4 v4, s[60:61] offset:2048
  v_mfma_f32_16x16x32_bf16 v[44:47], v[152:155], a[88:91], v[44:47]
  ds_read_b64_tr_b16 v[136:137], v17 offset:18432
  v_mfma_f32_16x16x32_bf16 v[64:67], v[152:155], a[92:95], v[64:67]
  s_waitcnt lgkmcnt(7)
  ds_read_b64_tr_b16 v[138:139], v17 offset:20736
  global_load_lds_dwordx4 v5, s[60:61] offset:3072
  v_mfma_f32_16x16x32_bf16 v[72:75], a[0:3], v[120:123], 0
  s_mul_i32 s79, s3, 1728
  ds_read_b64_tr_b16 v[140:141], v15 offset:23040
  v_mfma_f32_16x16x32_bf16 v[92:95], a[4:7], v[120:123], 0
  s_add_u32 s60, s6, s79
  ds_read_b64_tr_b16 v[142:143], v15 offset:25344
  s_waitcnt lgkmcnt(8)
  v_mfma_f32_16x16x32_bf16 v[76:79], a[0:3], v[124:127], 0
  s_addc_u32 s61, s7, 0
  ds_read_b64_tr_b16 v[144:145], v15 offset:23080
  v_mfma_f32_16x16x32_bf16 v[96:99], a[4:7], v[124:127], 0
  s_add_u32 m0, s52, 0
  ds_read_b64_tr_b16 v[146:147], v15 offset:25384
  global_load_lds_dwordx4 v6, s[60:61] offset:0
  s_waitcnt lgkmcnt(8)
  v_mfma_f32_16x16x32_bf16 v[80:83], a[0:3], v[128:131], 0
  ds_read_b64_tr_b16 v[148:149], v15 offset:23112
  v_mfma_f32_16x16x32_bf16 v[100:103], a[4:7], v[128:131], 0
  s_waitcnt lgkmcnt(7)
  ds_read_b64_tr_b16 v[150:151], v15 offset:25416
  global_load_lds_dwordx4 v7, s[60:61] offset:1008
  v_mfma_f32_16x16x32_bf16 v[84:87], a[0:3], v[132:135], 0
  ds_read_b64_tr_b16 v[152:153], v15 offset:23152
  v_mfma_f32_16x16x32_bf16 v[104:107], a[4:7], v[132:135], 0
  ds_read_b64_tr_b16 v[154:155], v15 offset:25456
  s_mov_b64 exec, 0x3ffff
  global_load_lds_dwordx4 v8, s[60:61] offset:2016
  s_mov_b64 exec, -1
  s_waitcnt lgkmcnt(8)
  v_mfma_f32_16x16x32_bf16 v[88:91], a[0:3], v[136:139], 0
  ds_read_b64_tr_b16 v[156:157], v17 offset:23040
  v_mfma_f32_16x16x32_bf16 v[108:111], a[4:7], v[136:139], 0
  ds_read_b64_tr_b16 v[158:159], v17 offset:25344
  v_add_u32 v13, s50, v241
  s_waitcnt vmcnt(10) lgkmcnt(8)
  v_mfma_f32_16x16x32_bf16 v[72:75], a[8:11], v[140:143], v[72:75]
  s_barrier
  ds_read_b128 a[96:99], v9 offset:0
  v_mfma_f32_16x16x32_bf16 v[92:95], a[12:15], v[140:143], v[92:95]
  s_mul_i32 s79, s33, 1728
  ds_read_b128 a[100:103], v9 offset:1024
  ds_read_b64_tr_b16 v[136:137], v17 offset:27648
  s_waitcnt lgkmcnt(9)
  v_mfma_f32_16x16x32_bf16 v[76:79], a[8:11], v[144:147], v[76:79]
  s_add_u32 s60, s10, s79
  ds_read_b64_tr_b16 v[138:139], v17 offset:29952
  v_mfma_f32_16x16x32_bf16 v[96:99], a[12:15], v[144:147], v[96:99]
  s_addc_u32 s61, s11, 0
  s_mov_b64 exec, s[82:83]
  ds_read_b128 v[136:139], v13 offset:0
  s_mov_b64 exec, -1
  s_waitcnt lgkmcnt(9)
  v_mfma_f32_16x16x32_bf16 v[80:83], a[8:11], v[148:151], v[80:83]
  s_add_u32 m0, s52, 9216
  ds_read_b64_tr_b16 v[120:121], v11 offset:27648
  ds_read_b64_tr_b16 v[122:123], v11 offset:29952
  global_load_lds_dwordx4 v6, s[60:61] offset:0
  v_mfma_f32_16x16x32_bf16 v[100:103], a[12:15], v[148:151], v[100:103]
  s_waitcnt lgkmcnt(9)
  ds_read_b64_tr_b16 v[124:125], v11 offset:27656
  v_mfma_f32_16x16x32_bf16 v[84:87], a[8:11], v[152:155], v[84:87]
  ds_read_b64_tr_b16 v[126:127], v11 offset:29960
  global_load_lds_dwordx4 v7, s[60:61] offset:1008
  v_mfma_f32_16x16x32_bf16 v[104:107], a[12:15], v[152:155], v[104:107]
  s_waitcnt lgkmcnt(9)
  ds_read_b64_tr_b16 v[128:129], v11 offset:27720
  ds_read_b64_tr_b16 v[130:131], v11 offset:30024
  v_mfma_f32_16x16x32_bf16 v[88:91], a[8:11], v[156:159], v[88:91]
  ds_read_b64_tr_b16 v[132:133], v11 offset:27728
  s_mov_b64 exec, 0x3ffff
  global_load_lds_dwordx4 v8, s[60:61] offset:2016
  s_mov_b64 exec, -1
  v_mfma_f32_16x16x32_bf16 v[108:111], a[12:15], v[156:159], v[108:111]
  s_add_u32 s60, s4, s74
  ds_read_b64_tr_b16 v[134:135], v11 offset:30032
  s_waitcnt lgkmcnt(8)
  v_mfma_f32_16x16x32_bf16 v[48:51], v[136:139], a[96:99], v[48:51]
  s_addc_u32 s61, s5, 0
  ds_read_b128 a[104:107], v10 offset:0
  ds_read_b128 a[108:111], v10 offset:1024
  v_mfma_f32_16x16x32_bf16 v[68:71], v[136:139], a[100:103], v[68:71]
  s_add_u32 m0, s51, 8192
  ds_read_b64_tr_b16 v[156:157], v17 offset:32256
  global_load_lds_dwordx4 v2, s[60:61] offset:0
  s_waitcnt lgkmcnt(9)
  v_mfma_f32_16x16x32_bf16 v[32:35], v[120:123], a[96:99], v[32:35]
  ds_read_b64_tr_b16 v[158:159], v17 offset:34560
  v_mfma_f32_16x16x32_bf16 v[52:55], v[120:123], a[100:103], v[52:55]
  s_mov_b64 exec, s[82:83]
  ds_read_b128 v[156:159], v13 offset:64
  s_mov_b64 exec, -1
  ds_read_b64_tr_b16 v[140:141], v11 offset:32256
  global_load_lds_dwordx4 v3, s[60:61] offset:1024
  s_waitcnt lgkmcnt(10)
  v_mfma_f32_16x16x32_bf16 v[36:39], v[124:127], a[96:99], v[36:39]
  ds_read_b64_tr_b16 v[142:143], v11 offset:34560
  v_mfma_f32_16x16x32_bf16 v[56:59], v[124:127], a[100:103], v[56:59]
  s_waitcnt lgkmcnt(9)
  ds_read_b64_tr_b16 v[144:145], v11 offset:32264
  global_load_lds_dwordx4 v4, s[60:61] offset:2048
  v_mfma_f32_16x16x32_bf16 v[40:43], v[128:131], a[96:99], v[40:43]
  ds_read_b64_tr_b16 v[146:147], v11 offset:34568
  ds_read_b64_tr_b16 v[148:149], v11 offset:32328
  v_mfma_f32_16x16x32_bf16 v[60:63], v[128:131], a[100:103], v[60:63]
  s_waitcnt lgkmcnt(10)
  ds_read_b64_tr_b16 v[150:151], v11 offset:34632
  global_load_lds_dwordx4 v5, s[60:61] offset:3072
  v_mfma_f32_16x16x32_bf16 v[44:47], v[132:135], a[96:99], v[44:47]
  ds_read_b64_tr_b16 v[152:153], v11 offset:32336
  v_mfma_f32_16x16x32_bf16 v[64:67], v[132:135], a[100:103], v[64:67]
  ds_read_b64_tr_b16 v[154:155], v11 offset:34640
  s_waitcnt vmcnt(14) lgkmcnt(8)
  v_mfma_f32_16x16x32_bf16 v[48:51], v[156:159], a[104:107], v[48:51]
  s_barrier
  ds_read_b64_tr_b16 v[120:121], v15 offset:36864
  v_mfma_f32_16x16x32_bf16 v[68:71], v[156:159], a[108:111], v[68:71]
  s_mul_i32 s79, s74, 1728
  ds_read_b64_tr_b16 v[122:123], v15 offset:39168
  s_waitcnt lgkmcnt(8)
  v_mfma_f32_16x16x32_bf16 v[32:35], v[140:143], a[104:107], v[32:35]
  s_add_u32 s60, s6, s79
  ds_read_b64_tr_b16 v[124:125], v15 offset:36904
  v_mfma_f32_16x16x32_bf16 v[52:55], v[140:143], a[108:111], v[52:55]
  s_addc_u32 s61, s7, 0
  ds_read_b64_tr_b16 v[126:127], v15 offset:39208
  s_waitcnt lgkmcnt(8)
  v_mfma_f32_16x16x32_bf16 v[36:39], v[144:147], a[104:107], v[36:39]
  s_add_u32 m0, s52, 18432
  ds_read_b64_tr_b16 v[128:129], v15 offset:36936
  global_load_lds_dwordx4 v6, s[60:61] offset:0
  v_mfma_f32_16x16x32_bf16 v[56:59], v[144:147], a[108:111], v[56:59]
  s_waitcnt lgkmcnt(7)
  ds_read_b64_tr_b16 v[130:131], v15 offset:39240
  v_mfma_f32_16x16x32_bf16 v[40:43], v[148:151], a[104:107], v[40:43]
  ds_read_b64_tr_b16 v[132:133], v15 offset:36976
  global_load_lds_dwordx4 v7, s[60:61] offset:1008
  v_mfma_f32_16x16x32_bf16 v[60:63], v[148:151], a[108:111], v[60:63]
  s_waitcnt lgkmcnt(7)
  ds_read_b64_tr_b16 v[134:135], v15 offset:39280
  v_mfma_f32_16x16x32_bf16 v[44:47], v[152:155], a[104:107], v[44:47]
  ds_read_b64_tr_b16 v[136:137], v17 offset:36864
  s_mov_b64 exec, 0x3ffff
  global_load_lds_dwordx4 v8, s[60:61] offset:2016
  s_mov_b64 exec, -1
  v_mfma_f32_16x16x32_bf16 v[64:67], v[152:155], a[108:111], v[64:67]
  s_waitcnt lgkmcnt(7)
  ds_read_b64_tr_b16 v[138:139], v17 offset:39168
  v_mfma_f32_16x16x32_bf16 v[72:75], a[16:19], v[120:123], v[72:75]
  ds_read_b64_tr_b16 v[140:141], v15 offset:41472
  v_mfma_f32_16x16x32_bf16 v[92:95], a[20:23], v[120:123], v[92:95]
  s_waitcnt lgkmcnt(7)
  ds_read_b64_tr_b16 v[142:143], v15 offset:43776
  v_mfma_f32_16x16x32_bf16 v[76:79], a[16:19], v[124:127], v[76:79]
  ds_read_b64_tr_b16 v[144:145], v15 offset:41512
  v_mfma_f32_16x16x32_bf16 v[96:99], a[20:23], v[124:127], v[96:99]
  s_waitcnt lgkmcnt(7)
  ds_read_b64_tr_b16 v[146:147], v15 offset:43816
  v_mfma_f32_16x16x32_bf16 v[80:83], a[16:19], v[128:131], v[80:83]
  ds_read_b64_tr_b16 v[148:149], v15 offset:41544
  v_mfma_f32_16x16x32_bf16 v[100:103], a[20:23], v[128:131], v[100:103]
  s_waitcnt lgkmcnt(7)
  ds_read_b64_tr_b16 v[150:151], v15 offset:43848
  v_mfma_f32_16x16x32_bf16 v[84:87], a[16:19], v[132:135], v[84:87]
  ds_read_b64_tr_b16 v[152:153], v15 offset:41584
  v_mfma_f32_16x16x32_bf16 v[104:107], a[20:23], v[132:135], v[104:107]
  s_waitcnt lgkmcnt(7)
  ds_read_b64_tr_b16 v[154:155], v15 offset:43888
  v_mfma_f32_16x16x32_bf16 v[88:91], a[16:19], v[136:139], v[88:91]
  ds_read_b64_tr_b16 v[156:157], v17 offset:41472
  v_mfma_f32_16x16x32_bf16 v[108:111], a[20:23], v[136:139], v[108:111]
  ds_read_b64_tr_b16 v[158:159], v17 offset:43776
  v_add_u32 v13, s3, v241
L_pad_1:
  s_cbranch_execz L_pad_5
  s_waitcnt vmcnt(10) lgkmcnt(8)
  v_mfma_f32_16x16x32_bf16 v[72:75], a[24:27], v[140:143], v[72:75]
  s_barrier
  ds_read_b128 a[112:115], v9 offset:4096
  v_mfma_f32_16x16x32_bf16 v[92:95], a[28:31], v[140:143], v[92:95]
  s_mul_i32 s79, s36, 1728
  ds_read_b128 a[116:119], v9 offset:5120
  ds_read_b64_tr_b16 v[136:137], v17 offset:0
  s_waitcnt lgkmcnt(9)
  v_mfma_f32_16x16x32_bf16 v[76:79], a[24:27], v[144:147], v[76:79]
  s_add_u32 s60, s10, s79
  ds_read_b64_tr_b16 v[138:139], v17 offset:2304
  v_mfma_f32_16x16x32_bf16 v[96:99], a[28:31], v[144:147], v[96:99]
  s_addc_u32 s61, s11, 0
  s_mov_b64 exec, s[82:83]
  ds_read_b128 v[136:139], v13 offset:0
  s_mov_b64 exec, -1
  s_waitcnt lgkmcnt(9)
  v_mfma_f32_16x16x32_bf16 v[80:83], a[24:27], v[148:151], v[80:83]
  s_add_u32 m0, s52, 27648
  ds_read_b64_tr_b16 v[120:121], v11 offset:0
  ds_read_b64_tr_b16 v[122:123], v11 offset:2304
  global_load_lds_dwordx4 v6, s[60:61] offset:0
  v_mfma_f32_16x16x32_bf16 v[100:103], a[28:31], v[148:151], v[100:103]
  s_waitcnt lgkmcnt(9)
  ds_read_b64_tr_b16 v[124:125], v11 offset:8
  v_mfma_f32_16x16x32_bf16 v[84:87], a[24:27], v[152:155], v[84:87]
  ds_read_b64_tr_b16 v[126:127], v11 offset:2312
  global_load_lds_dwordx4 v7, s[60:61] offset:1008
  v_mfma_f32_16x16x32_bf16 v[104:107], a[28:31], v[152:155], v[104:107]
  s_waitcnt lgkmcnt(9)
  ds_read_b64_tr_b16 v[128:129], v11 offset:72
  ds_read_b64_tr_b16 v[130:131], v11 offset:2376
  v_mfma_f32_16x16x32_bf16 v[88:91], a[24:27], v[156:159], v[88:91]
  ds_read_b64_tr_b16 v[132:133], v11 offset:80
  s_mov_b64 exec, 0x3ffff
  global_load_lds_dwordx4 v8, s[60:61] offset:2016
  s_mov_b64 exec, -1
  v_mfma_f32_16x16x32_bf16 v[108:111], a[28:31], v[156:159], v[108:111]
  s_mul_i32 s79, s37, 1728
  ds_read_b64_tr_b16 v[134:135], v11 offset:2384
  s_waitcnt lgkmcnt(8)
  v_mfma_f32_16x16x32_bf16 v[48:51], v[136:139], a[112:115], v[48:51]
  s_add_u32 s60, s10, s79
  ds_read_b128 a[120:123], v10 offset:4096
  ds_read_b128 a[124:127], v10 offset:5120
  v_mfma_f32_16x16x32_bf16 v[68:71], v[136:139], a[116:119], v[68:71]
  s_addc_u32 s61, s11, 0
  ds_read_b64_tr_b16 v[156:157], v17 offset:4608
  s_waitcnt lgkmcnt(9)
  v_mfma_f32_16x16x32_bf16 v[32:35], v[120:123], a[112:115], v[32:35]
  s_add_u32 m0, s52, 46080
  ds_read_b64_tr_b16 v[158:159], v17 offset:6912
  global_load_lds_dwordx4 v6, s[60:61] offset:0
  v_mfma_f32_16x16x32_bf16 v[52:55], v[120:123], a[116:119], v[52:55]
  s_mov_b64 exec, s[82:83]
  ds_read_b128 v[156:159], v13 offset:64
  s_mov_b64 exec, -1
  ds_read_b64_tr_b16 v[140:141], v11 offset:4608
  s_waitcnt lgkmcnt(10)
  v_mfma_f32_16x16x32_bf16 v[36:39], v[124:127], a[112:115], v[36:39]
  ds_read_b64_tr_b16 v[142:143], v11 offset:6912
  global_load_lds_dwordx4 v7, s[60:61] offset:1008
  v_mfma_f32_16x16x32_bf16 v[56:59], v[124:127], a[116:119], v[56:59]
  s_waitcnt lgkmcnt(9)
  ds_read_b64_tr_b16 v[144:145], v11 offset:4616
  v_mfma_f32_16x16x32_bf16 v[40:43], v[128:131], a[112:115], v[40:43]
  ds_read_b64_tr_b16 v[146:147], v11 offset:6920
  ds_read_b64_tr_b16 v[148:149], v11 offset:4680
  s_mov_b64 exec, 0x3ffff
  global_load_lds_dwordx4 v8, s[60:61] offset:2016
  s_mov_b64 exec, -1
  v_mfma_f32_16x16x32_bf16 v[60:63], v[128:131], a[116:119], v[60:63]
  s_waitcnt lgkmcnt(10)
  ds_read_b64_tr_b16 v[150:151], v11 offset:6984
  v_mfma_f32_16x16x32_bf16 v[44:47], v[132:135], a[112:115], v[44:47]
  ds_read_b64_tr_b16 v[152:153], v11 offset:4688
  v_mfma_f32_16x16x32_bf16 v[64:67], v[132:135], a[116:119], v[64:67]
  ds_read_b64_tr_b16 v[154:155], v11 offset:6992
  s_waitcnt vmcnt(13) lgkmcnt(8)
  v_mfma_f32_16x16x32_bf16 v[48:51], v[156:159], a[120:123], v[48:51]
  s_barrier
  ds_read_b64_tr_b16 v[120:121], v15 offset:9216
  v_mfma_f32_16x16x32_bf16 v[68:71], v[156:159], a[124:127], v[68:71]
  s_mul_i32 s79, s49, 1728
  ds_read_b64_tr_b16 v[122:123], v15 offset:11520
  v_add_u32 v232, 0x7f4a7c15, v232
  s_waitcnt lgkmcnt(8)
  v_mfma_f32_16x16x32_bf16 v[32:35], v[140:143], a[120:123], v[32:35]
  s_add_u32 s60, s10, s79
  ds_read_b64_tr_b16 v[124:125], v15 offset:9256
  v_add_u32 v233, 0x9e3779b9, v233
  v_mfma_f32_16x16x32_bf16 v[52:55], v[140:143], a[124:127], v[52:55]
  s_addc_u32 s61, s11, 0
  ds_read_b64_tr_b16 v[126:127], v15 offset:11560
  v_readfirstlane_b32 s0, v232
  s_waitcnt lgkmcnt(8)
  v_mfma_f32_16x16x32_bf16 v[36:39], v[144:147], a[120:123], v[36:39]
  s_add_u32 m0, s52, 36864
  ds_read_b64_tr_b16 v[128:129], v15 offset:9288
  global_load_lds_dwordx4 v6, s[60:61] offset:0
  v_mfma_f32_16x16x32_bf16 v[56:59], v[144:147], a[124:127], v[56:59]
  s_waitcnt lgkmcnt(7)
  ds_read_b64_tr_b16 v[130:131], v15 offset:11592
  v_readfirstlane_b32 s1, v233
  v_mfma_f32_16x16x32_bf16 v[40:43], v[148:151], a[120:123], v[40:43]
  ds_read_b64_tr_b16 v[132:133], v15 offset:9328
  global_load_lds_dwordx4 v7, s[60:61] offset:1008
  v_mfma_f32_16x16x32_bf16 v[60:63], v[148:151], a[124:127], v[60:63]
  s_waitcnt lgkmcnt(7)
  ds_read_b64_tr_b16 v[134:135], v15 offset:11632
  v_mfma_f32_16x16x32_bf16 v[44:47], v[152:155], a[120:123], v[44:47]
  ds_read_b64_tr_b16 v[136:137], v17 offset:9216
  s_mov_b64 exec, 0x3ffff
  global_load_lds_dwordx4 v8, s[60:61] offset:2016
  s_mov_b64 exec, -1
  v_mfma_f32_16x16x32_bf16 v[64:67], v[152:155], a[124:127], v[64:67]
  s_waitcnt lgkmcnt(7)
  ds_read_b64_tr_b16 v[138:139], v17 offset:11520
  v_mfma_f32_16x16x32_bf16 v[72:75], a[32:35], v[120:123], v[72:75]
  ds_read_b64_tr_b16 v[140:141], v15 offset:13824
  v_mfma_f32_16x16x32_bf16 v[92:95], a[36:39], v[120:123], v[92:95]
  s_waitcnt lgkmcnt(7)
  ds_read_b64_tr_b16 v[142:143], v15 offset:16128
  v_mfma_f32_16x16x32_bf16 v[76:79], a[32:35], v[124:127], v[76:79]
  ds_read_b64_tr_b16 v[144:145], v15 offset:13864
  v_mfma_f32_16x16x32_bf16 v[96:99], a[36:39], v[124:127], v[96:99]
  s_waitcnt lgkmcnt(7)
  ds_read_b64_tr_b16 v[146:147], v15 offset:16168
  v_mfma_f32_16x16x32_bf16 v[80:83], a[32:35], v[128:131], v[80:83]
  ds_read_b64_tr_b16 v[148:149], v15 offset:13896
  v_mfma_f32_16x16x32_bf16 v[100:103], a[36:39], v[128:131], v[100:103]
  s_waitcnt lgkmcnt(7)
  ds_read_b64_tr_b16 v[150:151], v15 offset:16200
  v_mfma_f32_16x16x32_bf16 v[84:87], a[32:35], v[132:135], v[84:87]
  ds_read_b64_tr_b16 v[152:153], v15 offset:13936
  v_mfma_f32_16x16x32_bf16 v[104:107], a[36:39], v[132:135], v[104:107]
  s_waitcnt lgkmcnt(7)
  ds_read_b64_tr_b16 v[154:155], v15 offset:16240
  v_mfma_f32_16x16x32_bf16 v[88:91], a[32:35], v[136:139], v[88:91]
  ds_read_b64_tr_b16 v[156:157], v17 offset:13824
  v_mfma_f32_16x16x32_bf16 v[108:111], a[36:39], v[136:139], v[108:111]
  ds_read_b64_tr_b16 v[158:159], v17 offset:16128
  v_add_u32 v13, s74, v241
  s_waitcnt vmcnt(9) lgkmcnt(8)
  v_mfma_f32_16x16x32_bf16 v[72:75], a[40:43], v[140:143], v[72:75]
  s_barrier
  ds_read_b128 a[128:131], v9 offset:8192
  v_mfma_f32_16x16x32_bf16 v[92:95], a[44:47], v[140:143], v[92:95]
  s_mul_i32 s79, s50, 1728
  ds_read_b128 a[132:135], v9 offset:9216
  ds_read_b64_tr_b16 v[136:137], v17 offset:18432
  s_waitcnt lgkmcnt(9)
  v_mfma_f32_16x16x32_bf16 v[76:79], a[40:43], v[144:147], v[76:79]
  s_add_u32 s60, s10, s79
  ds_read_b64_tr_b16 v[138:139], v17 offset:20736
  v_mfma_f32_16x16x32_bf16 v[96:99], a[44:47], v[144:147], v[96:99]
  s_addc_u32 s61, s11, 0
  s_mov_b64 exec, s[82:83]
  ds_read_b128 v[136:139], v13 offset:0
  s_mov_b64 exec, -1
  s_waitcnt lgkmcnt(9)
  v_mfma_f32_16x16x32_bf16 v[80:83], a[40:43], v[148:151], v[80:83]
  s_add_u32 m0, s52, 0
  ds_read_b64_tr_b16 v[120:121], v11 offset:18432
  ds_read_b64_tr_b16 v[122:123], v11 offset:20736
  global_load_lds_dwordx4 v6, s[60:61] offset:0
  v_mfma_f32_16x16x32_bf16 v[100:103], a[44:47], v[148:151], v[100:103]
  s_waitcnt lgkmcnt(9)
  ds_read_b64_tr_b16 v[124:125], v11 offset:18440
  v_mfma_f32_16x16x32_bf16 v[84:87], a[40:43], v[152:155], v[84:87]
  ds_read_b64_tr_b16 v[126:127], v11 offset:20744
  global_load_lds_dwordx4 v7, s[60:61] offset:1008
  v_mfma_f32_16x16x32_bf16 v[104:107], a[44:47], v[152:155], v[104:107]
  s_waitcnt lgkmcnt(9)
  ds_read_b64_tr_b16 v[128:129], v11 offset:18504
  ds_read_b64_tr_b16 v[130:131], v11 offset:20808
  v_mfma_f32_16x16x32_bf16 v[88:91], a[40:43], v[156:159], v[88:91]
  ds_read_b64_tr_b16 v[132:133], v11 offset:18512
  s_mov_b64 exec, 0x3ffff
  global_load_lds_dwordx4 v8, s[60:61] offset:2016
  s_mov_b64 exec, -1
  v_mfma_f32_16x16x32_bf16 v[108:111], a[44:47], v[156:159], v[108:111]
  s_mul_i32 s79, s3, 1728
  ds_read_b64_tr_b16 v[134:135], v11 offset:20816
  s_waitcnt lgkmcnt(8)
  v_mfma_f32_16x16x32_bf16 v[48:51], v[136:139], a[128:131], v[48:51]
  s_add_u32 s60, s10, s79
  ds_read_b128 a[136:139], v10 offset:8192
  ds_read_b128 a[140:143], v10 offset:9216
  v_mfma_f32_16x16x32_bf16 v[68:71], v[136:139], a[132:135], v[68:71]
  s_addc_u32 s61, s11, 0
  ds_read_b64_tr_b16 v[156:157], v17 offset:23040
  s_waitcnt lgkmcnt(9)
  v_mfma_f32_16x16x32_bf16 v[32:35], v[120:123], a[128:131], v[32:35]
  s_add_u32 m0, s52, 55296
  ds_read_b64_tr_b16 v[158:159], v17 offset:25344
  global_load_lds_dwordx4 v6, s[60:61] offset:0
  v_mfma_f32_16x16x32_bf16 v[52:55], v[120:123], a[132:135], v[52:55]
  s_mov_b64 exec, s[82:83]
  ds_read_b128 v[156:159], v13 offset:64
  s_mov_b64 exec, -1
  ds_read_b64_tr_b16 v[140:141], v11 offset:23040
  s_waitcnt lgkmcnt(10)
  v_mfma_f32_16x16x32_bf16 v[36:39], v[124:127], a[128:131], v[36:39]
  ds_read_b64_tr_b16 v[142:143], v11 offset:25344
  global_load_lds_dwordx4 v7, s[60:61] offset:1008
  v_mfma_f32_16x16x32_bf16 v[56:59], v[124:127], a[132:135], v[56:59]
  s_waitcnt lgkmcnt(9)
  ds_read_b64_tr_b16 v[144:145], v11 offset:23048
  v_mfma_f32_16x16x32_bf16 v[40:43], v[128:131], a[128:131], v[40:43]
  ds_read_b64_tr_b16 v[146:147], v11 offset:25352
  ds_read_b64_tr_b16 v[148:149], v11 offset:23112
  s_mov_b64 exec, 0x3ffff
  global_load_lds_dwordx4 v8, s[60:61] offset:2016
  s_mov_b64 exec, -1
  v_mfma_f32_16x16x32_bf16 v[60:63], v[128:131], a[132:135], v[60:63]
  s_waitcnt lgkmcnt(10)
  ds_read_b64_tr_b16 v[150:151], v11 offset:25416
  v_mfma_f32_16x16x32_bf16 v[44:47], v[132:135], a[128:131], v[44:47]
  ds_read_b64_tr_b16 v[152:153], v11 offset:23120
  v_mfma_f32_16x16x32_bf16 v[64:67], v[132:135], a[132:135], v[64:67]
  ds_read_b64_tr_b16 v[154:155], v11 offset:25424
  s_waitcnt vmcnt(12) lgkmcnt(8)
  v_mfma_f32_16x16x32_bf16 v[48:51], v[156:159], a[136:139], v[48:51]
  s_barrier
  ds_read_b64_tr_b16 v[120:121], v15 offset:27648
  v_mfma_f32_16x16x32_bf16 v[68:71], v[156:159], a[140:143], v[68:71]
  s_mul_i32 s79, s74, 1728
  ds_read_b64_tr_b16 v[122:123], v15 offset:29952
  s_waitcnt lgkmcnt(8)
  v_mfma_f32_16x16x32_bf16 v[32:35], v[140:143], a[136:139], v[32:35]
  s_add_u32 s60, s10, s79
  ds_read_b64_tr_b16 v[124:125], v15 offset:27688
  v_mfma_f32_16x16x32_bf16 v[52:55], v[140:143], a[140:143], v[52:55]
  s_addc_u32 s61, s11, 0
  ds_read_b64_tr_b16 v[126:127], v15 offset:29992
  s_waitcnt lgkmcnt(8)
  v_mfma_f32_16x16x32_bf16 v[36:39], v[144:147], a[136:139], v[36:39]
  s_add_u32 m0, s52, 9216
  ds_read_b64_tr_b16 v[128:129], v15 offset:27720
  global_load_lds_dwordx4 v6, s[60:61] offset:0
  v_mfma_f32_16x16x32_bf16 v[56:59], v[144:147], a[140:143], v[56:59]
  s_waitcnt lgkmcnt(7)
  ds_read_b64_tr_b16 v[130:131], v15 offset:30024
  v_mfma_f32_16x16x32_bf16 v[40:43], v[148:151], a[136:139], v[40:43]
  ds_read_b64_tr_b16 v[132:133], v15 offset:27760
  global_load_lds_dwordx4 v7, s[60:61] offset:1008
  v_mfma_f32_16x16x32_bf16 v[60:63], v[148:151], a[140:143], v[60:63]
  s_waitcnt lgkmcnt(7)
  ds_read_b64_tr_b16 v[134:135], v15 offset:30064
  v_mfma_f32_16x16x32_bf16 v[44:47], v[152:155], a[136:139], v[44:47]
  ds_read_b64_tr_b16 v[136:137], v17 offset:27648
  s_mov_b64 exec, 0x3ffff
  global_load_lds_dwordx4 v8, s[60:61] offset:2016
  s_mov_b64 exec, -1
  v_mfma_f32_16x16x32_bf16 v[64:67], v[152:155], a[140:143], v[64:67]
  s_mul_i32 s79, s34, 1728
  ds_read_b64_tr_b16 v[138:139], v17 offset:29952
  s_waitcnt lgkmcnt(8)
  v_mfma_f32_16x16x32_bf16 v[72:75], a[48:51], v[120:123], v[72:75]
  s_add_u32 s60, s8, s79
  ds_read_b64_tr_b16 v[140:141], v15 offset:32256
  v_mul_f32 v32, s90, v32
  v_mfma_f32_16x16x32_bf16 v[92:95], a[52:55], v[120:123], v[92:95]
  s_addc_u32 s61, s9, 0
  ds_read_b64_tr_b16 v[142:143], v15 offset:34560
  v_mul_f32 v33, s90, v33
  s_waitcnt lgkmcnt(8)
  v_mfma_f32_16x16x32_bf16 v[76:79], a[48:51], v[124:127], v[76:79]
  s_add_u32 m0, s52, 64512
  ds_read_b64_tr_b16 v[144:145], v15 offset:32296
  global_load_lds_dwordx4 v6, s[60:61] offset:0
  v_mfma_f32_16x16x32_bf16 v[96:99], a[52:55], v[124:127], v[96:99]
  s_waitcnt lgkmcnt(7)
  ds_read_b64_tr_b16 v[146:147], v15 offset:34600
  v_mul_f32 v34, s90, v34
  v_mfma_f32_16x16x32_bf16 v[80:83], a[48:51], v[128:131], v[80:83]
  ds_read_b64_tr_b16 v[148:149], v15 offset:32328
  global_load_lds_dwordx4 v7, s[60:61] offset:1008
  v_mfma_f32_16x16x32_bf16 v[100:103], a[52:55], v[128:131], v[100:103]
  s_waitcnt lgkmcnt(7)
  ds_read_b64_tr_b16 v[150:151], v15 offset:34632
  v_mul_f32 v35, s90, v35
  v_mfma_f32_16x16x32_bf16 v[84:87], a[48:51], v[132:135], v[84:87]
  ds_read_b64_tr_b16 v[152:153], v15 offset:32368
  s_mov_b64 exec, 0x3ffff
  global_load_lds_dwordx4 v8, s[60:61] offset:2016
  s_mov_b64 exec, -1
  v_mfma_f32_16x16x32_bf16 v[104:107], a[52:55], v[132:135], v[104:107]
  s_waitcnt lgkmcnt(7)
  ds_read_b64_tr_b16 v[154:155], v15 offset:34672
  v_mul_f32 v36, s90, v36
  v_mfma_f32_16x16x32_bf16 v[88:91], a[48:51], v[136:139], v[88:91]
  ds_read_b64_tr_b16 v[156:157], v17 offset:32256
  v_mul_f32 v37, s90, v37
  v_mfma_f32_16x16x32_bf16 v[108:111], a[52:55], v[136:139], v[108:111]
  ds_read_b64_tr_b16 v[158:159], v17 offset:34560
  v_mul_f32 v38, s90, v38
  s_waitcnt vmcnt(15) lgkmcnt(8)
  v_mfma_f32_16x16x32_bf16 v[72:75], a[56:59], v[140:143], v[72:75]
  s_barrier
  ds_read_b64_tr_b16 v[120:121], v15 offset:46080
  v_mfma_f32_16x16x32_bf16 v[92:95], a[60:63], v[140:143], v[92:95]
  s_mul_i32 s79, s32, 1728
  ds_read_b64_tr_b16 v[122:123], v15 offset:48384
  v_mul_f32 v39, s90, v39
  s_waitcnt lgkmcnt(8)
  v_mfma_f32_16x16x32_bf16 v[76:79], a[56:59], v[144:147], v[76:79]
  s_add_u32 s60, s8, s79
  ds_read_b64_tr_b16 v[124:125], v15 offset:46120
  v_cvt_pk_bf16_f32 v216, v32, v33
  v_mfma_f32_16x16x32_bf16 v[96:99], a[60:63], v[144:147], v[96:99]
  s_addc_u32 s61, s9, 0
  ds_read_b64_tr_b16 v[126:127], v15 offset:48424
  v_cvt_pk_bf16_f32 v217, v34, v35
  s_waitcnt lgkmcnt(8)
  v_mfma_f32_16x16x32_bf16 v[80:83], a[56:59], v[148:151], v[80:83]
  s_add_u32 m0, s52, 18432
  ds_read_b64_tr_b16 v[128:129], v15 offset:46152
  global_load_lds_dwordx4 v6, s[60:61] offset:0
  v_mfma_f32_16x16x32_bf16 v[100:103], a[60:63], v[148:151], v[100:103]
  s_waitcnt lgkmcnt(7)
  ds_read_b64_tr_b16 v[130:131], v15 offset:48456
  v_cvt_pk_bf16_f32 v218, v36, v37
  v_mfma_f32_16x16x32_bf16 v[84:87], a[56:59], v[152:155], v[84:87]
  ds_read_b64_tr_b16 v[132:133], v15 offset:46192
  global_load_lds_dwordx4 v7, s[60:61] offset:1008
  v_mfma_f32_16x16x32_bf16 v[104:107], a[60:63], v[152:155], v[104:107]
  s_waitcnt lgkmcnt(7)
  ds_read_b64_tr_b16 v[134:135], v15 offset:48496
  v_cvt_pk_bf16_f32 v219, v38, v39
  v_mfma_f32_16x16x32_bf16 v[88:91], a[56:59], v[156:159], v[88:91]
  ds_read_b64_tr_b16 v[136:137], v17 offset:46080
  s_mov_b64 exec, 0x3ffff
  global_load_lds_dwordx4 v8, s[60:61] offset:2016
  s_mov_b64 exec, -1
  v_mfma_f32_16x16x32_bf16 v[108:111], a[60:63], v[156:159], v[108:111]
  s_mul_i32 s79, s33, 1728
  ds_read_b64_tr_b16 v[138:139], v17 offset:48384
  v_mul_f32 v52, s90, v52
  s_waitcnt lgkmcnt(8)
  v_mfma_f32_16x16x32_bf16 v[72:75], a[64:67], v[120:123], v[72:75]
  s_add_u32 s60, s8, s79
  ds_read_b64_tr_b16 v[140:141], v15 offset:50688
  v_mul_f32 v53, s90, v53
  v_mfma_f32_16x16x32_bf16 v[92:95], a[68:71], v[120:123], v[92:95]
  s_addc_u32 s61, s9, 0
  ds_read_b64_tr_b16 v[142:143], v15 offset:52992
  v_mul_f32 v54, s90, v54
  s_waitcnt lgkmcnt(8)
  v_mfma_f32_16x16x32_bf16 v[76:79], a[64:67], v[124:127], v[76:79]
  s_add_u32 m0, s52, 73728
  ds_read_b64_tr_b16 v[144:145], v15 offset:50728
  global_load_lds_dwordx4 v6, s[60:61] offset:0
  v_mfma_f32_16x16x32_bf16 v[96:99], a[68:71], v[124:127], v[96:99]
  s_waitcnt lgkmcnt(7)
  ds_read_b64_tr_b16 v[146:147], v15 offset:53032
  v_mul_f32 v55, s90, v55
  v_mfma_f32_16x16x32_bf16 v[80:83], a[64:67], v[128:131], v[80:83]
  ds_read_b64_tr_b16 v[148:149], v15 offset:50760
  global_load_lds_dwordx4 v7, s[60:61] offset:1008
  v_mfma_f32_16x16x32_bf16 v[100:103], a[68:71], v[128:131], v[100:103]
  s_waitcnt lgkmcnt(7)
  ds_read_b64_tr_b16 v[150:151], v15 offset:53064
  v_mul_f32 v56, s90, v56
  v_mfma_f32_16x16x32_bf16 v[84:87], a[64:67], v[132:135], v[84:87]
  ds_read_b64_tr_b16 v[152:153], v15 offset:50800
  s_mov_b64 exec, 0x3ffff
  global_load_lds_dwordx4 v8, s[60:61] offset:2016
  s_mov_b64 exec, -1
  v_mfma_f32_16x16x32_bf16 v[104:107], a[68:71], v[132:135], v[104:107]
  s_waitcnt lgkmcnt(7)
  ds_read_b64_tr_b16 v[154:155], v15 offset:53104
  v_mul_f32 v57, s90, v57
  v_mfma_f32_16x16x32_bf16 v[88:91], a[64:67], v[136:139], v[88:91]
  ds_read_b64_tr_b16 v[156:157], v17 offset:50688
  v_mul_f32 v58, s90, v58
  v_mfma_f32_16x16x32_bf16 v[108:111], a[68:71], v[136:139], v[108:111]
  ds_read_b64_tr_b16 v[158:159], v17 offset:52992
  v_mul_f32 v59, s90, v59
  s_waitcnt vmcnt(18) lgkmcnt(8)
  v_mfma_f32_16x16x32_bf16 v[72:75], a[72:75], v[140:143], v[72:75]
  s_barrier
  ds_read_b64_tr_b16 v[120:121], v15 offset:36864
  v_mfma_f32_16x16x32_bf16 v[92:95], a[76:79], v[140:143], v[92:95]
  s_waitcnt lgkmcnt(7)
  ds_read_b64_tr_b16 v[122:123], v15 offset:39168
  v_cvt_pk_bf16_f32 v220, v52, v53
  v_mfma_f32_16x16x32_bf16 v[76:79], a[72:75], v[144:147], v[76:79]
  s_mul_i32 s79, s36, 1728
  ds_read_b64_tr_b16 v[124:125], v15 offset:36904
  v_cvt_pk_bf16_f32 v221, v54, v55
  v_mfma_f32_16x16x32_bf16 v[96:99], a[76:79], v[144:147], v[96:99]
  s_waitcnt lgkmcnt(7)
  ds_read_b64_tr_b16 v[126:127], v15 offset:39208
  v_cvt_pk_bf16_f32 v222, v56, v57
  v_mfma_f32_16x16x32_bf16 v[80:83], a[72:75], v[148:151], v[80:83]
  s_add_u32 s60, s8, s79
  ds_read_b64_tr_b16 v[128:129], v15 offset:36936
  v_cvt_pk_bf16_f32 v223, v58, v59
  v_mfma_f32_16x16x32_bf16 v[100:103], a[76:79], v[148:151], v[100:103]
  s_waitcnt lgkmcnt(7)
  ds_read_b64_tr_b16 v[130:131], v15 offset:39240
  v_mul_f32 v40, s90, v40
  v_mfma_f32_16x16x32_bf16 v[84:87], a[72:75], v[152:155], v[84:87]
  s_addc_u32 s61, s9, 0
  ds_read_b64_tr_b16 v[132:133], v15 offset:36976
  v_mul_f32 v41, s90, v41
  v_mfma_f32_16x16x32_bf16 v[104:107], a[76:79], v[152:155], v[104:107]
  s_waitcnt lgkmcnt(7)
  ds_read_b64_tr_b16 v[134:135], v15 offset:39280
  v_mul_f32 v42, s90, v42
  v_mfma_f32_16x16x32_bf16 v[88:91], a[72:75], v[156:159], v[88:91]
  s_add_u32 m0, s52, 27648
  ds_read_b64_tr_b16 v[136:137], v17 offset:36864
  global_load_lds_dwordx4 v6, s[60:61] offset:0
  v_mfma_f32_16x16x32_bf16 v[108:111], a[76:79], v[156:159], v[108:111]
  s_waitcnt lgkmcnt(7)
  ds_read_b64_tr_b16 v[138:139], v17 offset:39168
  v_mul_f32 v43, s90, v43
  v_mfma_f32_16x16x32_bf16 v[72:75], a[80:83], v[120:123], v[72:75]
  ds_read_b64_tr_b16 v[140:141], v15 offset:41472
  global_load_lds_dwordx4 v7, s[60:61] offset:1008
  v_mfma_f32_16x16x32_bf16 v[92:95], a[84:87], v[120:123], v[92:95]
  s_waitcnt lgkmcnt(7)
  ds_read_b64_tr_b16 v[142:143], v15 offset:43776
  v_mul_f32 v44, s90, v44
  v_mfma_f32_16x16x32_bf16 v[76:79], a[80:83], v[124:127], v[76:79]
  ds_read_b64_tr_b16 v[144:145], v15 offset:41512
  s_mov_b64 exec, 0x3ffff
  global_load_lds_dwordx4 v8, s[60:61] offset:2016
  s_mov_b64 exec, -1
  v_mfma_f32_16x16x32_bf16 v[96:99], a[84:87], v[124:127], v[96:99]
  s_waitcnt lgkmcnt(7)
  ds_read_b64_tr_b16 v[146:147], v15 offset:43816
  v_mul_f32 v45, s90, v45
  v_mfma_f32_16x16x32_bf16 v[80:83], a[80:83], v[128:131], v[80:83]
  ds_read_b64_tr_b16 v[148:149], v15 offset:41544
  v_mul_f32 v46, s90, v46
  v_mfma_f32_16x16x32_bf16 v[100:103], a[84:87], v[128:131], v[100:103]
  s_waitcnt lgkmcnt(7)
  ds_read_b64_tr_b16 v[150:151], v15 offset:43848
  v_mul_f32 v47, s90, v47
  v_mfma_f32_16x16x32_bf16 v[84:87], a[80:83], v[132:135], v[84:87]
  ds_read_b64_tr_b16 v[152:153], v15 offset:41584
  v_cvt_pk_bf16_f32 v224, v40, v41
  v_mfma_f32_16x16x32_bf16 v[104:107], a[84:87], v[132:135], v[104:107]
  s_waitcnt lgkmcnt(7)
  ds_read_b64_tr_b16 v[154:155], v15 offset:43888
  v_cvt_pk_bf16_f32 v225, v42, v43
  v_mfma_f32_16x16x32_bf16 v[88:91], a[80:83], v[136:139], v[88:91]
  ds_read_b64_tr_b16 v[156:157], v17 offset:41472
  v_cvt_pk_bf16_f32 v226, v44, v45
  v_mfma_f32_16x16x32_bf16 v[108:111], a[84:87], v[136:139], v[108:111]
  ds_read_b64_tr_b16 v[158:159], v17 offset:43776
  v_cvt_pk_bf16_f32 v227, v46, v47
  s_waitcnt vmcnt(18) lgkmcnt(8)
  v_mfma_f32_16x16x32_bf16 v[72:75], a[88:91], v[140:143], v[72:75]
  s_barrier
  ds_read_b64_tr_b16 v[120:121], v15 offset:0
  v_mfma_f32_16x16x32_bf16 v[92:95], a[92:95], v[140:143], v[92:95]
  s_waitcnt lgkmcnt(7)
  ds_read_b64_tr_b16 v[122:123], v15 offset:2304
  v_mul_f32 v60, s90, v60
  v_mfma_f32_16x16x32_bf16 v[76:79], a[88:91], v[144:147], v[76:79]
  s_mul_i32 s79, s37, 1728
  ds_read_b64_tr_b16 v[124:125], v15 offset:40
  v_mul_f32 v61, s90, v61
  v_mfma_f32_16x16x32_bf16 v[96:99], a[92:95], v[144:147], v[96:99]
  s_waitcnt lgkmcnt(7)
  ds_read_b64_tr_b16 v[126:127], v15 offset:2344
  v_mul_f32 v62, s90, v62
  v_mfma_f32_16x16x32_bf16 v[80:83], a[88:91], v[148:151], v[80:83]
  s_add_u32 s60, s8, s79
  ds_read_b64_tr_b16 v[128:129], v15 offset:72
  v_mul_f32 v63, s90, v63
  v_mfma_f32_16x16x32_bf16 v[100:103], a[92:95], v[148:151], v[100:103]
  s_waitcnt lgkmcnt(7)
  ds_read_b64_tr_b16 v[130:131], v15 offset:2376
  v_mul_f32 v64, s90, v64
  v_mfma_f32_16x16x32_bf16 v[84:87], a[88:91], v[152:155], v[84:87]
  s_addc_u32 s61, s9, 0
  ds_read_b64_tr_b16 v[132:133], v15 offset:112
  v_mul_f32 v65, s90, v65
  v_mfma_f32_16x16x32_bf16 v[104:107], a[92:95], v[152:155], v[104:107]
  s_waitcnt lgkmcnt(7)
  ds_read_b64_tr_b16 v[134:135], v15 offset:2416
  v_mul_f32 v66, s90, v66
  v_mfma_f32_16x16x32_bf16 v[88:91], a[88:91], v[156:159], v[88:91]
  s_add_u32 m0, s52, 46080
  ds_read_b64_tr_b16 v[136:137], v17 offset:0
  global_load_lds_dwordx4 v6, s[60:61] offset:0
  v_mfma_f32_16x16x32_bf16 v[108:111], a[92:95], v[156:159], v[108:111]
  s_waitcnt lgkmcnt(7)
  ds_read_b64_tr_b16 v[138:139], v17 offset:2304
  v_mul_f32 v67, s90, v67
  v_mfma_f32_16x16x32_bf16 v[72:75], a[96:99], v[120:123], v[72:75]
  ds_read_b64_tr_b16 v[140:141], v15 offset:4608
  global_load_lds_dwordx4 v7, s[60:61] offset:1008
  v_mfma_f32_16x16x32_bf16 v[92:95], a[100:103], v[120:123], v[92:95]
  s_waitcnt lgkmcnt(7)
  ds_read_b64_tr_b16 v[142:143], v15 offset:6912
  v_cvt_pk_bf16_f32 v228, v60, v61
  v_mfma_f32_16x16x32_bf16 v[76:79], a[96:99], v[124:127], v[76:79]
  ds_read_b64_tr_b16 v[144:145], v15 offset:4648
  s_mov_b64 exec, 0x3ffff
  global_load_lds_dwordx4 v8, s[60:61] offset:2016
  s_mov_b64 exec, -1
  v_mfma_f32_16x16x32_bf16 v[96:99], a[100:103], v[124:127], v[96:99]
  s_waitcnt lgkmcnt(7)
  ds_read_b64_tr_b16 v[146:147], v15 offset:6952
  v_cvt_pk_bf16_f32 v229, v62, v63
  v_mfma_f32_16x16x32_bf16 v[80:83], a[96:99], v[128:131], v[80:83]
  ds_read_b64_tr_b16 v[148:149], v15 offset:4680
  v_cvt_pk_bf16_f32 v230, v64, v65
  v_mfma_f32_16x16x32_bf16 v[100:103], a[100:103], v[128:131], v[100:103]
  s_waitcnt lgkmcnt(7)
  ds_read_b64_tr_b16 v[150:151], v15 offset:6984
  v_cvt_pk_bf16_f32 v231, v66, v67
  v_mfma_f32_16x16x32_bf16 v[84:87], a[96:99], v[132:135], v[84:87]
  ds_read_b64_tr_b16 v[152:153], v15 offset:4720
  v_mov_b32 v112, v48
  v_mfma_f32_16x16x32_bf16 v[104:107], a[100:103], v[132:135], v[104:107]
  s_waitcnt lgkmcnt(7)
  ds_read_b64_tr_b16 v[154:155], v15 offset:7024
  v_mov_b32 v116, v68
  v_mfma_f32_16x16x32_bf16 v[88:91], a[96:99], v[136:139], v[88:91]
  ds_read_b64_tr_b16 v[156:157], v17 offset:4608
  v_mul_f32 v48, s90, v48
  v_mfma_f32_16x16x32_bf16 v[108:111], a[100:103], v[136:139], v[108:111]
  ds_read_b64_tr_b16 v[158:159], v17 offset:6912
  v_mul_f32 v49, s90, v49
  s_waitcnt vmcnt(18) lgkmcnt(8)
  v_mfma_f32_16x16x32_bf16 v[72:75], a[104:107], v[140:143], v[72:75]
  s_barrier
  ds_read_b64_tr_b16 v[120:121], v15 offset:55296
  v_mfma_f32_16x16x32_bf16 v[92:95], a[108:111], v[140:143], v[92:95]
  s_waitcnt lgkmcnt(7)
  ds_read_b64_tr_b16 v[122:123], v15 offset:57600
  v_mul_f32 v50, s90, v50
  v_mfma_f32_16x16x32_bf16 v[76:79], a[104:107], v[144:147], v[76:79]
  s_mul_i32 s79, s49, 1728
  ds_read_b64_tr_b16 v[124:125], v15 offset:55336
  v_mul_f32 v51, s90, v51
  v_mfma_f32_16x16x32_bf16 v[96:99], a[108:111], v[144:147], v[96:99]
  s_waitcnt lgkmcnt(7)
  ds_read_b64_tr_b16 v[126:127], v15 offset:57640
  v_mul_f32 v68, s90, v68
  v_mfma_f32_16x16x32_bf16 v[80:83], a[104:107], v[148:151], v[80:83]
  s_add_u32 s60, s8, s79
  ds_read_b64_tr_b16 v[128:129], v15 offset:55368
  v_mul_f32 v69, s90, v69
  v_mfma_f32_16x16x32_bf16 v[100:103], a[108:111], v[148:151], v[100:103]
  s_waitcnt lgkmcnt(7)
  ds_read_b64_tr_b16 v[130:131], v15 offset:57672
  v_mul_f32 v70, s90, v70
  v_mfma_f32_16x16x32_bf16 v[84:87], a[104:107], v[152:155], v[84:87]
  s_addc_u32 s61, s9, 0
  ds_read_b64_tr_b16 v[132:133], v15 offset:55408
  v_mul_f32 v71, s90, v71
  v_mfma_f32_16x16x32_bf16 v[104:107], a[108:111], v[152:155], v[104:107]
  s_waitcnt lgkmcnt(7)
  ds_read_b64_tr_b16 v[134:135], v15 offset:57712
  v_cvt_pk_bf16_f32 v180, v48, v49
  v_mfma_f32_16x16x32_bf16 v[88:91], a[104:107], v[156:159], v[88:91]
  s_add_u32 m0, s52, 36864
  ds_read_b64_tr_b16 v[136:137], v17 offset:55296
  global_load_lds_dwordx4 v6, s[60:61] offset:0
  v_mfma_f32_16x16x32_bf16 v[108:111], a[108:111], v[156:159], v[108:111]
  s_waitcnt lgkmcnt(7)
  ds_read_b64_tr_b16 v[138:139], v17 offset:57600
  v_cvt_pk_bf16_f32 v181, v50, v51
  v_mfma_f32_16x16x32_bf16 v[72:75], a[112:115], v[120:123], v[72:75]
  ds_read_b64_tr_b16 v[140:141], v15 offset:59904
  global_load_lds_dwordx4 v7, s[60:61] offset:1008
  v_mfma_f32_16x16x32_bf16 v[92:95], a[116:119], v[120:123], v[92:95]
  s_waitcnt lgkmcnt(7)
  ds_read_b64_tr_b16 v[142:143], v15 offset:62208
  v_cvt_pk_bf16_f32 v182, v68, v69
  v_mfma_f32_16x16x32_bf16 v[76:79], a[112:115], v[124:127], v[76:79]
  ds_read_b64_tr_b16 v[144:145], v15 offset:59944
  s_mov_b64 exec, 0x3ffff
  global_load_lds_dwordx4 v8, s[60:61] offset:2016
  s_mov_b64 exec, -1
  v_mfma_f32_16x16x32_bf16 v[96:99], a[116:119], v[124:127], v[96:99]
  s_waitcnt lgkmcnt(7)
  ds_read_b64_tr_b16 v[146:147], v15 offset:62248
  v_cvt_pk_bf16_f32 v183, v70, v71
  v_mfma_f32_16x16x32_bf16 v[80:83], a[112:115], v[128:131], v[80:83]
  ds_read_b64_tr_b16 v[148:149], v15 offset:59976
  v_cvt_pk_bf16_f32 v112, 0, v112
  v_mfma_f32_16x16x32_bf16 v[100:103], a[116:119], v[128:131], v[100:103]
  s_waitcnt lgkmcnt(7)
  ds_read_b64_tr_b16 v[150:151], v15 offset:62280
  v_mul_f32 v112, 0xbfb8aa3b, v112
  v_mfma_f32_16x16x32_bf16 v[84:87], a[112:115], v[132:135], v[84:87]
  ds_read_b64_tr_b16 v[152:153], v15 offset:60016
  v_exp_f32 v112, v112
  v_mfma_f32_16x16x32_bf16 v[104:107], a[116:119], v[132:135], v[104:107]
  s_waitcnt lgkmcnt(7)
L_pad_2:
  s_cbranch_execz L_pad_6
  ds_read_b64_tr_b16 v[154:155], v15 offset:62320
  v_add_f32 v112, 1.0, v112
  v_mfma_f32_16x16x32_bf16 v[88:91], a[112:115], v[136:139], v[88:91]
  ds_read_b64_tr_b16 v[156:157], v17 offset:59904
  v_rcp_f32 v112, v112
  v_mfma_f32_16x16x32_bf16 v[108:111], a[116:119], v[136:139], v[108:111]
  ds_read_b64_tr_b16 v[158:159], v17 offset:62208
  v_cvt_pk_bf16_f32 v112, 0, v112
  s_waitcnt vmcnt(18) lgkmcnt(8)
  v_mfma_f32_16x16x32_bf16 v[72:75], a[120:123], v[140:143], v[72:75]
  s_barrier
  ds_read_b64_tr_b16 v[120:121], v15 offset:9216
  v_mfma_f32_16x16x32_bf16 v[92:95], a[124:127], v[140:143], v[92:95]
  s_waitcnt lgkmcnt(7)
  ds_read_b64_tr_b16 v[122:123], v15 offset:11520
  v_sub_f32 v113, 1.0, v112
  v_mfma_f32_16x16x32_bf16 v[76:79], a[120:123], v[144:147], v[76:79]
  s_mul_i32 s79, s50, 1728
  ds_read_b64_tr_b16 v[124:125], v15 offset:9256
  v_cvt_pk_bf16_f32 v113, 0, v113
  v_mfma_f32_16x16x32_bf16 v[96:99], a[124:127], v[144:147], v[96:99]
  s_waitcnt lgkmcnt(7)
  ds_read_b64_tr_b16 v[126:127], v15 offset:11560
  v_cndmask_b32 v112, v113, v112, s[66:67]
  v_mfma_f32_16x16x32_bf16 v[80:83], a[120:123], v[148:151], v[80:83]
  s_add_u32 s60, s8, s79
  ds_read_b64_tr_b16 v[128:129], v15 offset:9288
  ds_write_b32 v247, v112 offset:0
  v_mfma_f32_16x16x32_bf16 v[100:103], a[124:127], v[148:151], v[100:103]
  s_waitcnt lgkmcnt(8)
  ds_read_b64_tr_b16 v[130:131], v15 offset:11592
  v_cvt_pk_bf16_f32 v116, 0, v116
  v_mfma_f32_16x16x32_bf16 v[84:87], a[120:123], v[152:155], v[84:87]
  s_addc_u32 s61, s9, 0
  ds_read_b64_tr_b16 v[132:133], v15 offset:9328
  v_mul_f32 v116, 0xbfb8aa3b, v116
  v_mfma_f32_16x16x32_bf16 v[104:107], a[124:127], v[152:155], v[104:107]
  s_waitcnt lgkmcnt(8)
  ds_read_b64_tr_b16 v[134:135], v15 offset:11632
  v_exp_f32 v116, v116
  v_mfma_f32_16x16x32_bf16 v[88:91], a[120:123], v[156:159], v[88:91]
  s_add_u32 m0, s52, 0
  ds_read_b64_tr_b16 v[136:137], v17 offset:9216
  global_load_lds_dwordx4 v6, s[60:61] offset:0
  v_mfma_f32_16x16x32_bf16 v[108:111], a[124:127], v[156:159], v[108:111]
  s_waitcnt lgkmcnt(8)
  ds_read_b64_tr_b16 v[138:139], v17 offset:11520
  v_add_f32 v116, 1.0, v116
  v_mfma_f32_16x16x32_bf16 v[72:75], a[128:131], v[120:123], v[72:75]
  s_add_u32 s55, s54, 0
  ds_read_b64_tr_b16 v[140:141], v15 offset:13824
  global_load_lds_dwordx4 v7, s[60:61] offset:1008
  v_mfma_f32_16x16x32_bf16 v[92:95], a[132:135], v[120:123], v[92:95]
  s_waitcnt lgkmcnt(8)
  ds_read_b64_tr_b16 v[142:143], v15 offset:16128
  buffer_store_dwordx4 v[216:219], v14, s[12:15], s55 offen offset:0 sc1
  v_mfma_f32_16x16x32_bf16 v[76:79], a[128:131], v[124:127], v[76:79]
  s_add_u32 s56, s54, 0
  ds_read_b64_tr_b16 v[144:145], v15 offset:13864
  s_mov_b64 exec, 0x3ffff
  global_load_lds_dwordx4 v8, s[60:61] offset:2016
  s_mov_b64 exec, -1
  v_mfma_f32_16x16x32_bf16 v[96:99], a[132:135], v[124:127], v[96:99]
  s_waitcnt lgkmcnt(7)
  ds_read_b64_tr_b16 v[146:147], v15 offset:16168
  ds_write_b128 v14, v[216:219] offset:0
  v_mfma_f32_16x16x32_bf16 v[80:83], a[128:131], v[128:131], v[80:83]
  ds_read_b64_tr_b16 v[148:149], v15 offset:13896
  v_rcp_f32 v116, v116
  v_mfma_f32_16x16x32_bf16 v[100:103], a[132:135], v[128:131], v[100:103]
  s_waitcnt lgkmcnt(8)
  ds_read_b64_tr_b16 v[150:151], v15 offset:16200
  v_cvt_pk_bf16_f32 v116, 0, v116
  v_mfma_f32_16x16x32_bf16 v[84:87], a[128:131], v[132:135], v[84:87]
  ds_read_b64_tr_b16 v[152:153], v15 offset:13936
  v_sub_f32 v117, 1.0, v116
  v_mfma_f32_16x16x32_bf16 v[104:107], a[132:135], v[132:135], v[104:107]
  s_waitcnt lgkmcnt(8)
  ds_read_b64_tr_b16 v[154:155], v15 offset:16240
  ds_write_b128 v14, v[220:223] offset:128
  v_mfma_f32_16x16x32_bf16 v[88:91], a[128:131], v[136:139], v[88:91]
  ds_read_b64_tr_b16 v[156:157], v17 offset:13824
  v_cvt_pk_bf16_f32 v117, 0, v117
  v_mfma_f32_16x16x32_bf16 v[108:111], a[132:135], v[136:139], v[108:111]
  ds_read_b64_tr_b16 v[158:159], v17 offset:16128
  v_cndmask_b32 v116, v117, v116, s[66:67]
  s_waitcnt vmcnt(19) lgkmcnt(10)
  v_mfma_f32_16x16x32_bf16 v[72:75], a[136:139], v[140:143], v[72:75]
  s_barrier
  ds_read_b64_tr_b16 v[120:121], v12 offset:0
  v_mfma_f32_16x16x32_bf16 v[92:95], a[140:143], v[140:143], v[92:95]
  s_waitcnt lgkmcnt(9)
  ds_read_b64_tr_b16 v[122:123], v12 offset:2304
  ds_write_b32 v247, v116 offset:32
  v_mfma_f32_16x16x32_bf16 v[76:79], a[136:139], v[144:147], v[76:79]
  s_mul_i32 s79, s3, 1728
  ds_read_b64_tr_b16 v[124:125], v12 offset:8
  ds_write_b128 v14, v[224:227] offset:8192
  v_mfma_f32_16x16x32_bf16 v[96:99], a[140:143], v[144:147], v[96:99]
  s_waitcnt lgkmcnt(10)
  ds_read_b64_tr_b16 v[126:127], v12 offset:2312
  v_mfma_f32_16x16x32_bf16 v[80:83], a[136:139], v[148:151], v[80:83]
  s_add_u32 s60, s8, s79
  ds_read_b64_tr_b16 v[128:129], v12 offset:72
  buffer_store_dwordx4 v[220:223], v14, s[12:15], s56 offen offset:128 sc1
  v_mfma_f32_16x16x32_bf16 v[100:103], a[140:143], v[148:151], v[100:103]
  s_waitcnt lgkmcnt(10)
  ds_read_b64_tr_b16 v[130:131], v12 offset:2376
  v_mfma_f32_16x16x32_bf16 v[84:87], a[136:139], v[152:155], v[84:87]
  s_addc_u32 s61, s9, 0
  ds_read_b64_tr_b16 v[132:133], v12 offset:80
  ds_write_b128 v14, v[228:231] offset:8320
  v_mfma_f32_16x16x32_bf16 v[104:107], a[140:143], v[152:155], v[104:107]
  s_waitcnt lgkmcnt(10)
  ds_read_b64_tr_b16 v[134:135], v12 offset:2384
  v_mfma_f32_16x16x32_bf16 v[88:91], a[136:139], v[156:159], v[88:91]
  s_add_u32 m0, s52, 55296
  ds_read_b64_tr_b16 v[136:137], v18 offset:0
  global_load_lds_dwordx4 v6, s[60:61] offset:0
  v_mfma_f32_16x16x32_bf16 v[108:111], a[140:143], v[156:159], v[108:111]
  s_waitcnt lgkmcnt(10)
  ds_read_b64_tr_b16 v[138:139], v18 offset:2304
  v_mfma_f32_16x16x32_bf16 v[32:35], v[120:123], a[0:3], 0
  s_add_u32 s55, s54, 8192
  ds_read_b64_tr_b16 v[140:141], v12 offset:4608
  global_load_lds_dwordx4 v7, s[60:61] offset:1008
  v_mfma_f32_16x16x32_bf16 v[52:55], v[120:123], a[4:7], 0
  s_waitcnt lgkmcnt(8)
  ds_read_b64_tr_b16 v[142:143], v12 offset:6912
  ds_write_b128 v23, v[180:183] offset:16384
  v_mfma_f32_16x16x32_bf16 v[36:39], v[124:127], a[0:3], 0
  s_add_u32 s4, s12, s58
  ds_read_b64_tr_b16 v[144:145], v12 offset:4616
  s_mov_b64 exec, 0x3ffff
  global_load_lds_dwordx4 v8, s[60:61] offset:2016
  s_mov_b64 exec, -1
  v_mfma_f32_16x16x32_bf16 v[56:59], v[124:127], a[4:7], 0
  s_waitcnt lgkmcnt(9)
  ds_read_b64_tr_b16 v[146:147], v12 offset:6920
  v_cvt_pk_bf16_f32 v72, v72, v73
  v_mfma_f32_16x16x32_bf16 v[40:43], v[128:131], a[0:3], 0
  s_addc_u32 s5, s13, 0
  ds_read_b64_tr_b16 v[148:149], v12 offset:4680
  v_cvt_pk_bf16_f32 v73, v74, v75
  v_mfma_f32_16x16x32_bf16 v[60:63], v[128:131], a[4:7], 0
  s_waitcnt lgkmcnt(8)
  ds_read_b64_tr_b16 v[150:151], v12 offset:6984
  v_cvt_pk_bf16_f32 v74, v92, v93
  v_mfma_f32_16x16x32_bf16 v[44:47], v[132:135], a[0:3], 0
  s_cmp_ge_u32 s29, 2
  ds_read_b64_tr_b16 v[152:153], v12 offset:4688
  buffer_store_dwordx4 v[224:227], v14, s[12:15], s55 offen offset:0 sc1
  v_mfma_f32_16x16x32_bf16 v[64:67], v[132:135], a[4:7], 0
  s_waitcnt lgkmcnt(8)
  ds_read_b64_tr_b16 v[154:155], v12 offset:6992
  v_cvt_pk_bf16_f32 v75, v94, v95
  v_mfma_f32_16x16x32_bf16 v[48:51], v[136:139], a[0:3], 0
  s_cselect_b32 s6, 40960, 0
  ds_read_b64_tr_b16 v[156:157], v18 offset:4608
  v_cvt_pk_bf16_f32 v76, v76, v77
  v_mfma_f32_16x16x32_bf16 v[68:71], v[136:139], a[4:7], 0
  ds_read_b64_tr_b16 v[158:159], v18 offset:6912
  v_cvt_pk_bf16_f32 v77, v78, v79
  s_waitcnt vmcnt(21) lgkmcnt(9)
  v_mfma_f32_16x16x32_bf16 v[32:35], v[140:143], a[8:11], v[32:35]
  s_barrier
  ds_read_b64_tr_b16 v[120:121], v11 offset:18432
  v_mfma_f32_16x16x32_bf16 v[52:55], v[140:143], a[12:15], v[52:55]
  s_waitcnt lgkmcnt(7)
  ds_read_b64_tr_b16 v[122:123], v11 offset:20736
  v_cvt_pk_bf16_f32 v78, v96, v97
  v_mfma_f32_16x16x32_bf16 v[36:39], v[144:147], a[8:11], v[36:39]
  s_mul_i32 s79, s74, 1728
  ds_read_b64_tr_b16 v[124:125], v11 offset:18440
  v_cvt_pk_bf16_f32 v79, v98, v99
  v_mfma_f32_16x16x32_bf16 v[56:59], v[144:147], a[12:15], v[56:59]
  s_waitcnt lgkmcnt(7)
  ds_read_b64_tr_b16 v[126:127], v11 offset:20744
  v_cvt_pk_bf16_f32 v80, v80, v81
  v_mfma_f32_16x16x32_bf16 v[40:43], v[148:151], a[8:11], v[40:43]
  s_add_u32 s60, s8, s79
  ds_read_b64_tr_b16 v[128:129], v11 offset:18504
  v_cvt_pk_bf16_f32 v81, v82, v83
  v_mfma_f32_16x16x32_bf16 v[60:63], v[148:151], a[12:15], v[60:63]
  s_waitcnt lgkmcnt(7)
  ds_read_b64_tr_b16 v[130:131], v11 offset:20808
  v_cvt_pk_bf16_f32 v82, v100, v101
  v_mfma_f32_16x16x32_bf16 v[44:47], v[152:155], a[8:11], v[44:47]
  s_addc_u32 s61, s9, 0
  ds_read_b64_tr_b16 v[132:133], v11 offset:18512
  v_cvt_pk_bf16_f32 v83, v102, v103
  v_mfma_f32_16x16x32_bf16 v[64:67], v[152:155], a[12:15], v[64:67]
  s_waitcnt lgkmcnt(7)
  ds_read_b64_tr_b16 v[134:135], v11 offset:20816
  v_cvt_pk_bf16_f32 v84, v84, v85
  v_mfma_f32_16x16x32_bf16 v[48:51], v[156:159], a[8:11], v[48:51]
  s_add_u32 m0, s52, 9216
  ds_read_b64_tr_b16 v[136:137], v17 offset:18432
  global_load_lds_dwordx4 v6, s[60:61] offset:0
  v_mfma_f32_16x16x32_bf16 v[68:71], v[156:159], a[12:15], v[68:71]
  s_waitcnt lgkmcnt(7)
  ds_read_b64_tr_b16 v[138:139], v17 offset:20736
  v_cvt_pk_bf16_f32 v85, v86, v87
  v_mfma_f32_16x16x32_bf16 v[32:35], v[120:123], a[16:19], v[32:35]
  s_add_u32 s56, s54, 8192
  ds_read_b64_tr_b16 v[140:141], v11 offset:23040
  global_load_lds_dwordx4 v7, s[60:61] offset:1008
  v_mfma_f32_16x16x32_bf16 v[52:55], v[120:123], a[20:23], v[52:55]
  s_waitcnt lgkmcnt(7)
  ds_read_b64_tr_b16 v[142:143], v11 offset:25344
  buffer_store_dwordx4 v[228:231], v14, s[12:15], s56 offen offset:128 sc1
  v_mfma_f32_16x16x32_bf16 v[36:39], v[124:127], a[16:19], v[36:39]
  s_add_u32 s55, s54, 16384
  ds_read_b64_tr_b16 v[144:145], v11 offset:23048
  s_mov_b64 exec, 0x3ffff
  global_load_lds_dwordx4 v8, s[60:61] offset:2016
  s_mov_b64 exec, -1
  v_mfma_f32_16x16x32_bf16 v[56:59], v[124:127], a[20:23], v[56:59]
  s_waitcnt lgkmcnt(7)
  ds_read_b64_tr_b16 v[146:147], v11 offset:25352
  v_cvt_pk_bf16_f32 v86, v104, v105
  v_mfma_f32_16x16x32_bf16 v[40:43], v[128:131], a[16:19], v[40:43]
  s_mov_b32 s7, 0x20000
  ds_read_b64_tr_b16 v[148:149], v11 offset:23112
  v_cvt_pk_bf16_f32 v87, v106, v107
  v_mfma_f32_16x16x32_bf16 v[60:63], v[128:131], a[20:23], v[60:63]
  s_waitcnt lgkmcnt(7)
  ds_read_b64_tr_b16 v[150:151], v11 offset:25416
  v_cvt_pk_bf16_f32 v88, v88, v89
  v_mfma_f32_16x16x32_bf16 v[44:47], v[132:135], a[16:19], v[44:47]
  ds_read_b64_tr_b16 v[152:153], v11 offset:23120
  v_cvt_pk_bf16_f32 v89, v90, v91
  v_mfma_f32_16x16x32_bf16 v[64:67], v[132:135], a[20:23], v[64:67]
  s_waitcnt lgkmcnt(7)
  ds_read_b64_tr_b16 v[154:155], v11 offset:25424
  v_cvt_pk_bf16_f32 v90, v108, v109
  v_mfma_f32_16x16x32_bf16 v[48:51], v[136:139], a[16:19], v[48:51]
  ds_read_b64_tr_b16 v[156:157], v17 offset:23040
  v_cvt_pk_bf16_f32 v91, v110, v111
  v_mfma_f32_16x16x32_bf16 v[68:71], v[136:139], a[20:23], v[68:71]
  ds_read_b64_tr_b16 v[158:159], v17 offset:25344
  v_cndmask_b32 v88, v88, v160, s[82:83]
  s_waitcnt vmcnt(22) lgkmcnt(8)
  v_mfma_f32_16x16x32_bf16 v[32:35], v[140:143], a[24:27], v[32:35]
  s_barrier
  ds_read_b64_tr_b16 v[120:121], v12 offset:9216
  v_mfma_f32_16x16x32_bf16 v[52:55], v[140:143], a[28:31], v[52:55]
  s_waitcnt lgkmcnt(7)
  ds_read_b64_tr_b16 v[122:123], v12 offset:11520
  v_cndmask_b32 v89, v89, v160, s[82:83]
  v_mfma_f32_16x16x32_bf16 v[36:39], v[144:147], a[24:27], v[36:39]
  s_mul_i32 s48, s28, 36864
  ds_read_b64_tr_b16 v[124:125], v12 offset:9224
  v_cndmask_b32 v90, v90, v160, s[82:83]
  v_mfma_f32_16x16x32_bf16 v[56:59], v[144:147], a[28:31], v[56:59]
  s_waitcnt lgkmcnt(7)
  ds_read_b64_tr_b16 v[126:127], v12 offset:11528
  v_cndmask_b32 v91, v91, v160, s[82:83]
  v_mfma_f32_16x16x32_bf16 v[40:43], v[148:151], a[24:27], v[40:43]
  s_and_b32 s39, s28, 1
  ds_read_b64_tr_b16 v[128:129], v12 offset:9288
  buffer_store_dwordx4 v[180:183], v165, s[12:15], s55 offen offset:0 sc1
  v_mfma_f32_16x16x32_bf16 v[60:63], v[148:151], a[28:31], v[60:63]
  s_waitcnt lgkmcnt(7)
  ds_read_b64_tr_b16 v[130:131], v12 offset:11592
  v_lshrrev_b32 v26, 4, v1
  v_mfma_f32_16x16x32_bf16 v[44:47], v[152:155], a[24:27], v[44:47]
  s_add_u32 s55, s54, 20480
  ds_read_b64_tr_b16 v[132:133], v12 offset:9296
  v_bfe_u32 v27, v1, 2, 2
  v_mfma_f32_16x16x32_bf16 v[64:67], v[152:155], a[28:31], v[64:67]
  s_waitcnt lgkmcnt(7)
  ds_read_b64_tr_b16 v[134:135], v12 offset:11600
  v_and_b32 v28, 3, v1
  v_mfma_f32_16x16x32_bf16 v[48:51], v[156:159], a[24:27], v[48:51]
  s_mul_i32 s49, s39, 331776
  ds_read_b64_tr_b16 v[136:137], v18 offset:9216
  v_lshlrev_b32 v28, 3, v28
  v_mfma_f32_16x16x32_bf16 v[68:71], v[156:159], a[28:31], v[68:71]
  s_waitcnt lgkmcnt(7)
  ds_read_b64_tr_b16 v[138:139], v18 offset:11520
  v_add_u32 v28, s48, v28
  v_mfma_f32_16x16x32_bf16 v[32:35], v[120:123], a[32:35], v[32:35]
  s_lshl_b32 s39, s72, 7
  ds_read_b64_tr_b16 v[140:141], v12 offset:13824
  v_lshrrev_b32 v29, 1, v26
  v_mfma_f32_16x16x32_bf16 v[52:55], v[120:123], a[36:39], v[52:55]
  s_waitcnt lgkmcnt(7)
  ds_read_b64_tr_b16 v[142:143], v12 offset:16128
  v_and_b32 v30, 1, v26
  v_mfma_f32_16x16x32_bf16 v[36:39], v[124:127], a[32:35], v[36:39]
  s_add_u32 s49, s49, s39
  ds_read_b64_tr_b16 v[144:145], v12 offset:13832
  v_mul_u32_u24 v31, 20, v29
  v_mfma_f32_16x16x32_bf16 v[56:59], v[124:127], a[36:39], v[56:59]
  s_waitcnt lgkmcnt(7)
  ds_read_b64_tr_b16 v[146:147], v12 offset:16136
  v_lshl_add_u32 v31, v30, 2, v31
  v_mfma_f32_16x16x32_bf16 v[40:43], v[128:131], a[32:35], v[40:43]
  s_mul_i32 s51, s28, 36864
  ds_read_b64_tr_b16 v[148:149], v12 offset:13896
  v_add_u32 v31, v31, v27
  v_mfma_f32_16x16x32_bf16 v[60:63], v[128:131], a[36:39], v[60:63]
  s_waitcnt lgkmcnt(7)
  ds_read_b64_tr_b16 v[150:151], v12 offset:16200
  v_lshl_add_u32 v2, v31, 7, v28
  v_mfma_f32_16x16x32_bf16 v[44:47], v[132:135], a[32:35], v[44:47]
  s_and_b32 s39, s71, 3
  ds_read_b64_tr_b16 v[152:153], v12 offset:13904
  buffer_store_dwordx4 v[72:75], v23, s[12:15], s55 offen offset:0 sc1
  v_mfma_f32_16x16x32_bf16 v[64:67], v[132:135], a[36:39], v[64:67]
  s_waitcnt lgkmcnt(7)
  ds_read_b64_tr_b16 v[154:155], v12 offset:16208
  v_xor_b32 v29, v29, v30
  v_mfma_f32_16x16x32_bf16 v[48:51], v[136:139], a[32:35], v[48:51]
  s_add_u32 s56, s54, 24576
  ds_read_b64_tr_b16 v[156:157], v18 offset:13824
  v_lshrrev_b32 v30, 1, v27
  v_mfma_f32_16x16x32_bf16 v[68:71], v[136:139], a[36:39], v[68:71]
  ds_read_b64_tr_b16 v[158:159], v18 offset:16128
  v_lshl_add_u32 v29, v29, 1, v30
  s_waitcnt vmcnt(21) lgkmcnt(8)
  v_mfma_f32_16x16x32_bf16 v[32:35], v[140:143], a[40:43], v[32:35]
  s_barrier
  ds_read_b64_tr_b16 v[120:121], v11 offset:27648
  v_mfma_f32_16x16x32_bf16 v[52:55], v[140:143], a[44:47], v[52:55]
  s_waitcnt lgkmcnt(7)
  ds_read_b64_tr_b16 v[122:123], v11 offset:29952
  v_lshl_add_u32 v2, v29, 5, v2
  v_mfma_f32_16x16x32_bf16 v[36:39], v[144:147], a[40:43], v[36:39]
  s_lshl_b32 s39, s39, 1
  ds_read_b64_tr_b16 v[124:125], v11 offset:27656
  v_xor_b32 v3, 32, v2
  v_mfma_f32_16x16x32_bf16 v[56:59], v[144:147], a[44:47], v[56:59]
  s_waitcnt lgkmcnt(7)
  ds_read_b64_tr_b16 v[126:127], v11 offset:29960
  v_xor_b32 v4, 64, v2
  v_mfma_f32_16x16x32_bf16 v[40:43], v[148:151], a[40:43], v[40:43]
  s_lshl_b32 s32, s39, 12
  ds_read_b64_tr_b16 v[128:129], v11 offset:27720
  v_xor_b32 v5, 96, v2
  v_mfma_f32_16x16x32_bf16 v[60:63], v[148:151], a[44:47], v[60:63]
  s_waitcnt lgkmcnt(7)
  ds_read_b64_tr_b16 v[130:131], v11 offset:30024
  v_mul_u32_u24 v31, 72, v30
  v_mfma_f32_16x16x32_bf16 v[44:47], v[152:155], a[40:43], v[44:47]
  s_add_u32 s32, s32, s51
  ds_read_b64_tr_b16 v[132:133], v11 offset:27728
  v_and_b32 v27, 1, v27
  v_mfma_f32_16x16x32_bf16 v[64:67], v[152:155], a[44:47], v[64:67]
  s_waitcnt lgkmcnt(7)
  ds_read_b64_tr_b16 v[134:135], v11 offset:30032
  v_add3_u32 v31, v31, v27, 16
  v_mfma_f32_16x16x32_bf16 v[48:51], v[156:159], a[40:43], v[48:51]
  s_mul_i32 s26, s39, 36864
  ds_read_b64_tr_b16 v[136:137], v17 offset:27648
  v_mul_u32_u24 v29, 18, v26
  v_mfma_f32_16x16x32_bf16 v[68:71], v[156:159], a[44:47], v[68:71]
  s_waitcnt lgkmcnt(7)
  ds_read_b64_tr_b16 v[138:139], v17 offset:29952
  buffer_store_dwordx4 v[76:79], v23, s[12:15], s56 offen offset:0 sc1
  v_mfma_f32_16x16x32_bf16 v[32:35], v[120:123], a[48:51], v[32:35]
  s_add_u32 s55, s54, 28672
  ds_read_b64_tr_b16 v[140:141], v11 offset:32256
  ds_write_b128 v23, v[72:75] offset:23040
  v_mfma_f32_16x16x32_bf16 v[52:55], v[120:123], a[52:55], v[52:55]
  s_waitcnt lgkmcnt(8)
  ds_read_b64_tr_b16 v[142:143], v11 offset:34560
  v_and_b32 v30, 1, v26
  v_mfma_f32_16x16x32_bf16 v[36:39], v[124:127], a[48:51], v[36:39]
  s_add_u32 s36, s51, 36864
  ds_read_b64_tr_b16 v[144:145], v11 offset:32264
  v_lshlrev_b32 v30, 4, v30
  v_mfma_f32_16x16x32_bf16 v[56:59], v[124:127], a[52:55], v[56:59]
  s_waitcnt lgkmcnt(8)
  ds_read_b64_tr_b16 v[146:147], v11 offset:34568
  v_sub_u32 v29, v29, v30
  v_mfma_f32_16x16x32_bf16 v[40:43], v[128:131], a[48:51], v[40:43]
  s_add_u32 s49, s49, s16
  ds_read_b64_tr_b16 v[148:149], v11 offset:32328
  ds_write_b128 v23, v[76:79] offset:27136
  v_mfma_f32_16x16x32_bf16 v[60:63], v[128:131], a[52:55], v[60:63]
  s_waitcnt lgkmcnt(9)
  ds_read_b64_tr_b16 v[150:151], v11 offset:34632
  v_add_u32 v31, v31, v29
  v_mfma_f32_16x16x32_bf16 v[44:47], v[132:135], a[48:51], v[44:47]
  s_addc_u32 s57, s17, 0
  ds_read_b64_tr_b16 v[152:153], v11 offset:32336
  v_lshl_add_u32 v6, v31, 7, v28
  v_mfma_f32_16x16x32_bf16 v[64:67], v[132:135], a[52:55], v[64:67]
  s_waitcnt lgkmcnt(9)
  ds_read_b64_tr_b16 v[154:155], v11 offset:34640
  v_lshl_add_u32 v6, v26, 5, v6
  v_mfma_f32_16x16x32_bf16 v[48:51], v[136:139], a[48:51], v[48:51]
  ds_read_b64_tr_b16 v[156:157], v17 offset:32256
  ds_write_b128 v23, v[80:83] offset:31232
  v_mfma_f32_16x16x32_bf16 v[68:71], v[136:139], a[52:55], v[68:71]
  ds_read_b64_tr_b16 v[158:159], v17 offset:34560
  v_xor_b32 v7, 32, v6
  s_waitcnt vmcnt(19) lgkmcnt(10)
  v_mfma_f32_16x16x32_bf16 v[32:35], v[140:143], a[56:59], v[32:35]
  s_barrier
  ds_read_b64_tr_b16 v[120:121], v11 offset:46080
  v_mfma_f32_16x16x32_bf16 v[52:55], v[140:143], a[60:63], v[52:55]
  s_waitcnt lgkmcnt(9)
  ds_read_b64_tr_b16 v[122:123], v11 offset:48384
  v_xor_b32 v8, 64, v6
  v_mfma_f32_16x16x32_bf16 v[36:39], v[144:147], a[56:59], v[36:39]
  ds_read_b64_tr_b16 v[124:125], v11 offset:46088
  buffer_store_dwordx4 v[80:83], v23, s[12:15], s55 offen offset:0 sc1
  v_mfma_f32_16x16x32_bf16 v[56:59], v[144:147], a[60:63], v[56:59]
  s_waitcnt lgkmcnt(8)
  ds_read_b64_tr_b16 v[126:127], v11 offset:48392
  ds_write_b128 v23, v[84:87] offset:35328
  v_mfma_f32_16x16x32_bf16 v[40:43], v[148:151], a[56:59], v[40:43]
  s_add_u32 s56, s54, 32768
  ds_read_b64_tr_b16 v[128:129], v11 offset:46152
  v_xor_b32 v9, 96, v6
  v_mfma_f32_16x16x32_bf16 v[60:63], v[148:151], a[60:63], v[60:63]
  s_waitcnt lgkmcnt(9)
  ds_read_b64_tr_b16 v[130:131], v11 offset:48456
  v_mfma_f32_16x16x32_bf16 v[44:47], v[152:155], a[56:59], v[44:47]
  s_lshl_b32 s48, s28, 10
  ds_read_b64_tr_b16 v[132:133], v11 offset:46160
  v_mfma_f32_16x16x32_bf16 v[64:67], v[152:155], a[60:63], v[64:67]
  s_waitcnt lgkmcnt(8)
  ds_read_b64_tr_b16 v[134:135], v11 offset:48464
  ds_write_b128 v166, v[88:91] offset:39424
  v_mfma_f32_16x16x32_bf16 v[48:51], v[156:159], a[56:59], v[48:51]
  s_add_u32 s48, s48, 32768
  ds_read_b64_tr_b16 v[136:137], v17 offset:46080
  v_lshl_add_u32 v10, v1, 2, s48
  v_mfma_f32_16x16x32_bf16 v[68:71], v[156:159], a[60:63], v[68:71]
  s_waitcnt lgkmcnt(9)
  ds_read_b64_tr_b16 v[138:139], v17 offset:48384
  v_mfma_f32_16x16x32_bf16 v[32:35], v[120:123], a[64:67], v[32:35]
  s_lshl_b32 s48, s28, 13
  ds_read_b64_tr_b16 v[140:141], v11 offset:50688
  v_add_u32 v15, s48, v22
  v_mfma_f32_16x16x32_bf16 v[52:55], v[120:123], a[68:71], v[52:55]
  s_waitcnt lgkmcnt(9)
  ds_read_b64_tr_b16 v[142:143], v11 offset:52992
  v_add_u32 v16, 4096, v15
  v_mfma_f32_16x16x32_bf16 v[36:39], v[124:127], a[64:67], v[36:39]
  ds_read_b64_tr_b16 v[144:145], v11 offset:50696
  v_mfma_f32_16x16x32_bf16 v[56:59], v[124:127], a[68:71], v[56:59]
  s_waitcnt lgkmcnt(8)
  ds_read_b64_tr_b16 v[146:147], v11 offset:53000
  v_mfma_f32_16x16x32_bf16 v[40:43], v[128:131], a[64:67], v[40:43]
  ds_read_b64_tr_b16 v[148:149], v11 offset:50760
  buffer_store_dwordx4 v[84:87], v23, s[12:15], s56 offen offset:0 sc1
  v_mfma_f32_16x16x32_bf16 v[60:63], v[128:131], a[68:71], v[60:63]
  s_waitcnt lgkmcnt(8)
  ds_read_b64_tr_b16 v[150:151], v11 offset:53064
  v_mfma_f32_16x16x32_bf16 v[44:47], v[132:135], a[64:67], v[44:47]
  s_add_u32 s55, s54, 36864
  ds_read_b64_tr_b16 v[152:153], v11 offset:50768
  v_mfma_f32_16x16x32_bf16 v[64:67], v[132:135], a[68:71], v[64:67]
  s_waitcnt lgkmcnt(7)
  ds_read_b64_tr_b16 v[154:155], v11 offset:53072
  v_mfma_f32_16x16x32_bf16 v[48:51], v[136:139], a[64:67], v[48:51]
  ds_read_b64_tr_b16 v[156:157], v17 offset:50688
  v_mfma_f32_16x16x32_bf16 v[68:71], v[136:139], a[68:71], v[68:71]
  ds_read_b64_tr_b16 v[158:159], v17 offset:52992
  s_waitcnt vmcnt(18) lgkmcnt(8)
  v_mfma_f32_16x16x32_bf16 v[32:35], v[140:143], a[72:75], v[32:35]
  s_barrier
  ds_read_b64_tr_b16 v[120:121], v11 offset:36864
  v_mfma_f32_16x16x32_bf16 v[52:55], v[140:143], a[76:79], v[52:55]
  s_waitcnt lgkmcnt(7)
  ds_read_b64_tr_b16 v[122:123], v11 offset:39168
  v_mfma_f32_16x16x32_bf16 v[36:39], v[144:147], a[72:75], v[36:39]
  ds_read_b64_tr_b16 v[124:125], v11 offset:36872
  v_mfma_f32_16x16x32_bf16 v[56:59], v[144:147], a[76:79], v[56:59]
  s_waitcnt lgkmcnt(7)
  ds_read_b64_tr_b16 v[126:127], v11 offset:39176
  v_mfma_f32_16x16x32_bf16 v[40:43], v[148:151], a[72:75], v[40:43]
  ds_read_b64_tr_b16 v[128:129], v11 offset:36936
  v_mfma_f32_16x16x32_bf16 v[60:63], v[148:151], a[76:79], v[60:63]
  s_waitcnt lgkmcnt(7)
  ds_read_b64_tr_b16 v[130:131], v11 offset:39240
  v_mfma_f32_16x16x32_bf16 v[44:47], v[152:155], a[72:75], v[44:47]
  ds_read_b64_tr_b16 v[132:133], v11 offset:36944
  v_mfma_f32_16x16x32_bf16 v[64:67], v[152:155], a[76:79], v[64:67]
  s_waitcnt lgkmcnt(7)
  ds_read_b64_tr_b16 v[134:135], v11 offset:39248
  buffer_store_dwordx4 v[88:91], v166, s[12:15], s55 offen offset:0 sc1
  v_mfma_f32_16x16x32_bf16 v[48:51], v[156:159], a[72:75], v[48:51]
  ds_read_b64_tr_b16 v[136:137], v17 offset:36864
  v_mfma_f32_16x16x32_bf16 v[68:71], v[156:159], a[76:79], v[68:71]
  s_waitcnt lgkmcnt(7)
  ds_read_b64_tr_b16 v[138:139], v17 offset:39168
  buffer_load_dword a255, v162, s[16:19], 0 offen
  v_mfma_f32_16x16x32_bf16 v[32:35], v[120:123], a[80:83], v[32:35]
  ds_read_b64_tr_b16 v[140:141], v11 offset:41472
  v_mfma_f32_16x16x32_bf16 v[52:55], v[120:123], a[84:87], v[52:55]
  s_waitcnt lgkmcnt(7)
  ds_read_b64_tr_b16 v[142:143], v11 offset:43776
  v_mfma_f32_16x16x32_bf16 v[36:39], v[124:127], a[80:83], v[36:39]
  ds_read_b64_tr_b16 v[144:145], v11 offset:41480
  v_mfma_f32_16x16x32_bf16 v[56:59], v[124:127], a[84:87], v[56:59]
  s_waitcnt lgkmcnt(7)
  ds_read_b64_tr_b16 v[146:147], v11 offset:43784
  v_mfma_f32_16x16x32_bf16 v[40:43], v[128:131], a[80:83], v[40:43]
  ds_read_b64_tr_b16 v[148:149], v11 offset:41544
  v_mfma_f32_16x16x32_bf16 v[60:63], v[128:131], a[84:87], v[60:63]
  s_waitcnt lgkmcnt(7)
  ds_read_b64_tr_b16 v[150:151], v11 offset:43848
  v_mfma_f32_16x16x32_bf16 v[44:47], v[132:135], a[80:83], v[44:47]
  ds_read_b64_tr_b16 v[152:153], v11 offset:41552
  v_mfma_f32_16x16x32_bf16 v[64:67], v[132:135], a[84:87], v[64:67]
  s_waitcnt lgkmcnt(7)
  ds_read_b64_tr_b16 v[154:155], v11 offset:43856
  v_mfma_f32_16x16x32_bf16 v[48:51], v[136:139], a[80:83], v[48:51]
  ds_read_b64_tr_b16 v[156:157], v17 offset:41472
  v_mfma_f32_16x16x32_bf16 v[68:71], v[136:139], a[84:87], v[68:71]
  ds_read_b64_tr_b16 v[158:159], v17 offset:43776
  s_waitcnt vmcnt(16) lgkmcnt(8)
  v_mfma_f32_16x16x32_bf16 v[32:35], v[140:143], a[88:91], v[32:35]
  s_barrier
  ds_read_b64_tr_b16 v[120:121], v11 offset:0
  v_mfma_f32_16x16x32_bf16 v[52:55], v[140:143], a[92:95], v[52:55]
  s_waitcnt lgkmcnt(7)
  ds_read_b64_tr_b16 v[122:123], v11 offset:2304
  ds_read_b128 a[144:147], v19 offset:0
  v_mfma_f32_16x16x32_bf16 v[36:39], v[144:147], a[88:91], v[36:39]
  ds_read_b64_tr_b16 v[124:125], v11 offset:8
  v_mfma_f32_16x16x32_bf16 v[56:59], v[144:147], a[92:95], v[56:59]
  s_waitcnt lgkmcnt(8)
  ds_read_b64_tr_b16 v[126:127], v11 offset:2312
  ds_read_b128 a[148:151], v19 offset:1024
  v_mfma_f32_16x16x32_bf16 v[40:43], v[148:151], a[88:91], v[40:43]
  ds_read_b64_tr_b16 v[128:129], v11 offset:72
  v_mfma_f32_16x16x32_bf16 v[60:63], v[148:151], a[92:95], v[60:63]
  s_waitcnt lgkmcnt(9)
  ds_read_b64_tr_b16 v[130:131], v11 offset:2376
  ds_read_b128 a[152:155], v19 offset:2048
  v_mfma_f32_16x16x32_bf16 v[44:47], v[152:155], a[88:91], v[44:47]
  ds_read_b64_tr_b16 v[132:133], v11 offset:80
  v_mfma_f32_16x16x32_bf16 v[64:67], v[152:155], a[92:95], v[64:67]
  s_waitcnt lgkmcnt(10)
  ds_read_b64_tr_b16 v[134:135], v11 offset:2384
  ds_read_b128 a[156:159], v19 offset:3072
  v_mfma_f32_16x16x32_bf16 v[48:51], v[156:159], a[88:91], v[48:51]
  ds_read_b64_tr_b16 v[136:137], v17 offset:0
  v_mfma_f32_16x16x32_bf16 v[68:71], v[156:159], a[92:95], v[68:71]
  s_waitcnt lgkmcnt(11)
  ds_read_b64_tr_b16 v[138:139], v17 offset:2304
  ds_read_b32 a160, v20 offset:0
  v_mfma_f32_16x16x32_bf16 v[32:35], v[120:123], a[96:99], v[32:35]
  ds_read_b64_tr_b16 v[140:141], v11 offset:4608
  v_mfma_f32_16x16x32_bf16 v[52:55], v[120:123], a[100:103], v[52:55]
  s_waitcnt lgkmcnt(11)
  ds_read_b64_tr_b16 v[142:143], v11 offset:6912
  ds_read_b32 a162, v20 offset:1024
  v_mfma_f32_16x16x32_bf16 v[36:39], v[124:127], a[96:99], v[36:39]
  ds_read_b64_tr_b16 v[144:145], v11 offset:4616
  v_mfma_f32_16x16x32_bf16 v[56:59], v[124:127], a[100:103], v[56:59]
  s_waitcnt lgkmcnt(11)
  ds_read_b64_tr_b16 v[146:147], v11 offset:6920
  ds_read_b32 a164, v20 offset:2048
  v_mfma_f32_16x16x32_bf16 v[40:43], v[128:131], a[96:99], v[40:43]
  ds_read_b64_tr_b16 v[148:149], v11 offset:4680
  v_mfma_f32_16x16x32_bf16 v[60:63], v[128:131], a[100:103], v[60:63]
  s_waitcnt lgkmcnt(11)
  ds_read_b64_tr_b16 v[150:151], v11 offset:6984
  ds_read_b32 a166, v20 offset:3072
  v_mfma_f32_16x16x32_bf16 v[44:47], v[132:135], a[96:99], v[44:47]
  ds_read_b64_tr_b16 v[152:153], v11 offset:4688
  v_mfma_f32_16x16x32_bf16 v[64:67], v[132:135], a[100:103], v[64:67]
  s_waitcnt lgkmcnt(11)
  ds_read_b64_tr_b16 v[154:155], v11 offset:6992
  ds_read_b128 a[168:171], v21 offset:2560
  v_mfma_f32_16x16x32_bf16 v[48:51], v[136:139], a[96:99], v[48:51]
  ds_read_b64_tr_b16 v[156:157], v17 offset:4608
  v_mfma_f32_16x16x32_bf16 v[68:71], v[136:139], a[100:103], v[68:71]
  ds_read_b64_tr_b16 v[158:159], v17 offset:6912
  ds_read_b128 a[172:175], v21 offset:3072
  s_waitcnt vmcnt(12) lgkmcnt(13)
  v_mfma_f32_16x16x32_bf16 v[32:35], v[140:143], a[104:107], v[32:35]
  s_barrier
  ds_read_b64_tr_b16 v[120:121], v11 offset:55296
  v_mfma_f32_16x16x32_bf16 v[52:55], v[140:143], a[108:111], v[52:55]
  s_waitcnt lgkmcnt(11)
L_pad_3:
  s_cbranch_execz L_pad_7
  ds_read_b64_tr_b16 v[122:123], v11 offset:57600
  v_mfma_f32_16x16x32_bf16 v[36:39], v[144:147], a[104:107], v[36:39]
  ds_read_b64_tr_b16 v[124:125], v11 offset:55304
  ds_read_b128 a[176:179], v21 offset:3584
  v_mfma_f32_16x16x32_bf16 v[56:59], v[144:147], a[108:111], v[56:59]
  s_waitcnt lgkmcnt(11)
  ds_read_b64_tr_b16 v[126:127], v11 offset:57608
  v_mfma_f32_16x16x32_bf16 v[40:43], v[148:151], a[104:107], v[40:43]
  ds_read_b64_tr_b16 v[128:129], v11 offset:55368
  ds_read_b128 a[180:183], v21 offset:4096
  v_mfma_f32_16x16x32_bf16 v[60:63], v[148:151], a[108:111], v[60:63]
  s_waitcnt lgkmcnt(11)
  ds_read_b64_tr_b16 v[130:131], v11 offset:57672
  v_mfma_f32_16x16x32_bf16 v[44:47], v[152:155], a[104:107], v[44:47]
  ds_read_b64_tr_b16 v[132:133], v11 offset:55376
  ds_read_b128 a[184:187], v21 offset:4608
  v_mfma_f32_16x16x32_bf16 v[64:67], v[152:155], a[108:111], v[64:67]
  s_waitcnt lgkmcnt(11)
  ds_read_b64_tr_b16 v[134:135], v11 offset:57680
  v_mfma_f32_16x16x32_bf16 v[48:51], v[156:159], a[104:107], v[48:51]
  ds_read_b64_tr_b16 v[136:137], v17 offset:55296
  ds_read_b128 a[188:191], v21 offset:5120
  v_mfma_f32_16x16x32_bf16 v[68:71], v[156:159], a[108:111], v[68:71]
  s_waitcnt lgkmcnt(11)
  ds_read_b64_tr_b16 v[138:139], v17 offset:57600
  v_mfma_f32_16x16x32_bf16 v[32:35], v[120:123], a[112:115], v[32:35]
  s_waitcnt vmcnt(1)
  s_atomic_swap_x2 s[0:1], s[12:13], s63 offset:0x20000
  ds_read_b64_tr_b16 v[140:141], v11 offset:59904
  ds_read_b128 a[192:195], v21 offset:5632
  v_mfma_f32_16x16x32_bf16 v[52:55], v[120:123], a[116:119], v[52:55]
  s_waitcnt lgkmcnt(11)
  ds_read_b64_tr_b16 v[142:143], v11 offset:62208
  v_mfma_f32_16x16x32_bf16 v[36:39], v[124:127], a[112:115], v[36:39]
  ds_read_b64_tr_b16 v[144:145], v11 offset:59912
  ds_read_b128 a[196:199], v21 offset:6144
  v_mfma_f32_16x16x32_bf16 v[56:59], v[124:127], a[116:119], v[56:59]
  s_waitcnt lgkmcnt(11)
  ds_read_b64_tr_b16 v[146:147], v11 offset:62216
  v_mfma_f32_16x16x32_bf16 v[40:43], v[128:131], a[112:115], v[40:43]
  ds_read_b64_tr_b16 v[148:149], v11 offset:59976
  ds_read_b32 v242, v163 offset:22528
  v_mfma_f32_16x16x32_bf16 v[60:63], v[128:131], a[116:119], v[60:63]
  s_waitcnt lgkmcnt(11)
  ds_read_b64_tr_b16 v[150:151], v11 offset:62280
  v_mfma_f32_16x16x32_bf16 v[44:47], v[132:135], a[112:115], v[44:47]
  ds_read_b64_tr_b16 v[152:153], v11 offset:59984
  ds_read_b32 v243, v163 offset:22656
  v_mfma_f32_16x16x32_bf16 v[64:67], v[132:135], a[116:119], v[64:67]
  s_waitcnt lgkmcnt(11)
  ds_read_b64_tr_b16 v[154:155], v11 offset:62288
  v_mfma_f32_16x16x32_bf16 v[48:51], v[136:139], a[112:115], v[48:51]
  ds_read_b64_tr_b16 v[156:157], v17 offset:59904
  ds_read_b32 v244, v163 offset:22784
  v_mfma_f32_16x16x32_bf16 v[68:71], v[136:139], a[116:119], v[68:71]
  s_waitcnt lgkmcnt(11)
  ds_read_b64_tr_b16 v[158:159], v17 offset:62208
  v_mfma_f32_16x16x32_bf16 v[32:35], v[140:143], a[120:123], v[32:35]
  s_barrier
  ds_read_b64_tr_b16 v[120:121], v11 offset:9216
  v_mfma_f32_16x16x32_bf16 v[52:55], v[140:143], a[124:127], v[52:55]
  s_waitcnt lgkmcnt(10)
  ds_read_b64_tr_b16 v[122:123], v11 offset:11520
  ds_read_b32 v245, v163 offset:22912
  v_mfma_f32_16x16x32_bf16 v[36:39], v[144:147], a[120:123], v[36:39]
  ds_read_b64_tr_b16 v[124:125], v11 offset:9224
  v_mfma_f32_16x16x32_bf16 v[56:59], v[144:147], a[124:127], v[56:59]
  s_waitcnt lgkmcnt(10)
  ds_read_b64_tr_b16 v[126:127], v11 offset:11528
  v_mfma_f32_16x16x32_bf16 v[40:43], v[148:151], a[120:123], v[40:43]
  ds_read_b64_tr_b16 v[128:129], v11 offset:9288
  v_mfma_f32_16x16x32_bf16 v[60:63], v[148:151], a[124:127], v[60:63]
  s_waitcnt lgkmcnt(9)
  ds_read_b64_tr_b16 v[130:131], v11 offset:11592
  v_mfma_f32_16x16x32_bf16 v[44:47], v[152:155], a[120:123], v[44:47]
  ds_read_b64_tr_b16 v[132:133], v11 offset:9296
  v_mfma_f32_16x16x32_bf16 v[64:67], v[152:155], a[124:127], v[64:67]
  s_waitcnt lgkmcnt(8)
  ds_read_b64_tr_b16 v[134:135], v11 offset:11600
  v_mfma_f32_16x16x32_bf16 v[48:51], v[156:159], a[120:123], v[48:51]
  ds_read_b64_tr_b16 v[136:137], v17 offset:9216
  v_mfma_f32_16x16x32_bf16 v[68:71], v[156:159], a[124:127], v[68:71]
  s_waitcnt lgkmcnt(8)
  ds_read_b64_tr_b16 v[138:139], v17 offset:11520
  v_mfma_f32_16x16x32_bf16 v[32:35], v[120:123], a[128:131], v[32:35]
  ds_read_b64_tr_b16 v[156:157], v17 offset:13824
  ds_read_b64_tr_b16 v[158:159], v17 offset:16128
  v_mfma_f32_16x16x32_bf16 v[52:55], v[120:123], a[132:135], v[52:55]
  s_waitcnt lgkmcnt(8)
  ds_read_b64_tr_b16 v[140:141], v11 offset:13824
  v_mfma_f32_16x16x32_bf16 v[36:39], v[124:127], a[128:131], v[36:39]
  ds_read_b64_tr_b16 v[142:143], v11 offset:16128
  ds_read_b64_tr_b16 v[144:145], v11 offset:13832
  v_mfma_f32_16x16x32_bf16 v[56:59], v[124:127], a[132:135], v[56:59]
  s_waitcnt lgkmcnt(9)
  ds_read_b64_tr_b16 v[146:147], v11 offset:16136
  v_mfma_f32_16x16x32_bf16 v[40:43], v[128:131], a[128:131], v[40:43]
  ds_read_b64_tr_b16 v[148:149], v11 offset:13896
  ds_read_b64_tr_b16 v[150:151], v11 offset:16200
  v_mfma_f32_16x16x32_bf16 v[60:63], v[128:131], a[132:135], v[60:63]
  s_waitcnt lgkmcnt(8)
  ds_read_b64_tr_b16 v[152:153], v11 offset:13904
  v_mfma_f32_16x16x32_bf16 v[48:51], v[136:139], a[128:131], v[48:51]
  ds_read_b64_tr_b16 v[154:155], v11 offset:16208
  v_mfma_f32_16x16x32_bf16 v[68:71], v[136:139], a[132:135], v[68:71]
  s_waitcnt lgkmcnt(8)
  v_mfma_f32_16x16x32_bf16 v[48:51], v[156:159], a[136:139], v[48:51]
  v_mfma_f32_16x16x32_bf16 v[68:71], v[156:159], a[140:143], v[68:71]
  s_waitcnt lgkmcnt(6)
  v_mfma_f32_16x16x32_bf16 v[32:35], v[140:143], a[136:139], v[32:35]
  v_mfma_f32_16x16x32_bf16 v[52:55], v[140:143], a[140:143], v[52:55]
  s_waitcnt lgkmcnt(4)
  v_mfma_f32_16x16x32_bf16 v[36:39], v[144:147], a[136:139], v[36:39]
  s_nop 1
  v_cvt_pk_bf16_f32 v48, v48, v49
  v_cvt_pk_bf16_f32 v49, v50, v51
  v_mfma_f32_16x16x32_bf16 v[56:59], v[144:147], a[140:143], v[56:59]
  v_cvt_pk_bf16_f32 v50, v68, v69
  v_cvt_pk_bf16_f32 v51, v70, v71
  v_mfma_f32_16x16x32_bf16 v[44:47], v[132:135], a[128:131], v[44:47]
  ds_write_b128 v23, v[48:51] offset:59904
  v_mfma_f32_16x16x32_bf16 v[64:67], v[132:135], a[132:135], v[64:67]
  s_waitcnt lgkmcnt(3)
  v_cvt_pk_bf16_f32 v32, v32, v33
  v_cvt_pk_bf16_f32 v33, v34, v35
  v_mfma_f32_16x16x32_bf16 v[40:43], v[148:151], a[136:139], v[40:43]
  v_cvt_pk_bf16_f32 v34, v36, v37
  v_cvt_pk_bf16_f32 v35, v38, v39
  v_mfma_f32_16x16x32_bf16 v[60:63], v[148:151], a[140:143], v[60:63]
  s_waitcnt lgkmcnt(1)
  ds_write_b128 v14, v[32:35] offset:43520
  v_cvt_pk_bf16_f32 v52, v52, v53
  v_mfma_f32_16x16x32_bf16 v[44:47], v[152:155], a[136:139], v[44:47]
  v_cvt_pk_bf16_f32 v53, v54, v55
  v_cvt_pk_bf16_f32 v54, v56, v57
  v_mfma_f32_16x16x32_bf16 v[64:67], v[152:155], a[140:143], v[64:67]
  v_cvt_pk_bf16_f32 v55, v58, v59
  ds_write_b128 v14, v[52:55] offset:43648
  v_cvt_pk_bf16_f32 v40, v40, v41
  v_cvt_pk_bf16_f32 v41, v42, v43
  s_nop 0
  v_cvt_pk_bf16_f32 v42, v44, v45
  v_cvt_pk_bf16_f32 v43, v46, v47
  ds_write_b128 v14, v[40:43] offset:51712
  v_cvt_pk_bf16_f32 v60, v60, v61
  v_cvt_pk_bf16_f32 v61, v62, v63
  v_cvt_pk_bf16_f32 v62, v64, v65
  v_cvt_pk_bf16_f32 v63, v66, v67
  ds_write_b128 v14, v[60:63] offset:51840
  s_waitcnt lgkmcnt(0)
  s_barrier
  ds_read_b32 v174, v20 offset:46592
  ds_read_b128 a[76:79], v19 offset:46592
  ds_read_b32 v172, v20 offset:45568
  ds_read_b128 a[72:75], v19 offset:45568
  ds_read_b32 v170, v20 offset:44544
  ds_read_b128 a[68:71], v19 offset:44544
  ds_read_b32 v168, v20 offset:43520
  ds_read_b128 a[64:67], v19 offset:43520
  s_waitcnt lgkmcnt(6)
  v_mfma_f32_32x32x16_bf16 v[32:47], a[156:159], a[76:79], v[200:215]
  v_cndmask_b32 v174, 0, v174, s[64:65]
  s_waitcnt lgkmcnt(5)
  v_cndmask_b32 v172, 0, v172, s[64:65]
  s_waitcnt lgkmcnt(3)
  v_cndmask_b32 v170, 0, v170, s[64:65]
  s_waitcnt lgkmcnt(1)
  v_cndmask_b32 v168, 0, v168, s[64:65]
  s_nop 4
  v_cvt_pk_bf16_f32 v27, -v32, 0
  v_cndmask_b32 v175, 0, v27, s[64:65]
  s_nop 1
  v_mfma_f32_32x32x8_bf16 v[32:47], a[166:167], v[174:175], v[32:47]
  v_mfma_f32_32x32x16_bf16 v[48:63], a[152:155], a[76:79], 0
  s_nop 10
  v_exp_f32 v32, v32
  v_exp_f32 v33, v33
  v_exp_f32 v34, v34
  v_exp_f32 v35, v35
  v_cvt_pk_bf16_f32 v128, v32, v33
  v_exp_f32 v36, v36
  v_exp_f32 v37, v37
  v_cvt_pk_bf16_f32 v129, v34, v35
  v_exp_f32 v38, v38
  v_exp_f32 v39, v39
  v_cvt_pk_bf16_f32 v130, v36, v37
  v_mfma_f32_32x32x8_bf16 v[48:63], a[164:165], v[174:175], v[48:63]
  v_exp_f32 v40, v40
  v_exp_f32 v41, v41
  v_cvt_pk_bf16_f32 v131, v38, v39
  v_exp_f32 v42, v42
  v_exp_f32 v43, v43
  v_cvt_pk_bf16_f32 v132, v40, v41
  v_exp_f32 v44, v44
  v_exp_f32 v45, v45
  v_cvt_pk_bf16_f32 v133, v42, v43
  v_exp_f32 v46, v46
  v_exp_f32 v47, v47
  v_cvt_pk_bf16_f32 v134, v44, v45
  v_cvt_pk_bf16_f32 v135, v46, v47
  v_mfma_f32_32x32x16_bf16 v[32:47], a[148:151], a[76:79], 0
  s_waitcnt lgkmcnt(0)
  s_barrier
  v_exp_f32 v48, v48
  v_exp_f32 v49, v49
  v_exp_f32 v50, v50
  v_exp_f32 v51, v51
  v_cvt_pk_bf16_f32 v136, v48, v49
  v_mfma_f32_32x32x8_bf16 v[32:47], a[162:163], v[174:175], v[32:47]
  buffer_load_dwordx2 v[236:237], v239, s[12:15], 0 offen sc1
  v_exp_f32 v52, v52
  v_exp_f32 v53, v53
  v_cvt_pk_bf16_f32 v137, v50, v51
  v_exp_f32 v54, v54
  v_exp_f32 v55, v55
  v_cvt_pk_bf16_f32 v138, v52, v53
  v_mfma_f32_32x32x16_bf16 v[112:127], a[192:195], v[128:131], 0
  v_exp_f32 v56, v56
  v_exp_f32 v57, v57
  v_cvt_pk_bf16_f32 v139, v54, v55
  v_exp_f32 v58, v58
  v_exp_f32 v59, v59
  v_cvt_pk_bf16_f32 v140, v56, v57
  v_mfma_f32_32x32x16_bf16 v[112:127], a[196:199], v[132:135], v[112:127]
  v_exp_f32 v60, v60
  v_exp_f32 v61, v61
  v_cvt_pk_bf16_f32 v141, v58, v59
  v_exp_f32 v62, v62
  v_exp_f32 v63, v63
  v_cvt_pk_bf16_f32 v142, v60, v61
  v_cvt_pk_bf16_f32 v143, v62, v63
  v_mfma_f32_32x32x16_bf16 v[48:63], a[144:147], a[76:79], 0
  v_exp_f32 v32, v32
  v_exp_f32 v33, v33
  v_exp_f32 v34, v34
  v_exp_f32 v35, v35
  v_cvt_pk_bf16_f32 v128, v32, v33
  v_mfma_f32_32x32x8_bf16 v[48:63], a[160:161], v[174:175], v[48:63]
  v_exp_f32 v36, v36
  v_exp_f32 v37, v37
  v_cvt_pk_bf16_f32 v129, v34, v35
  v_exp_f32 v38, v38
  v_exp_f32 v39, v39
  v_cvt_pk_bf16_f32 v130, v36, v37
  v_mfma_f32_32x32x16_bf16 v[112:127], a[184:187], v[136:139], v[112:127]
  v_exp_f32 v40, v40
  v_exp_f32 v41, v41
  v_cvt_pk_bf16_f32 v131, v38, v39
  v_exp_f32 v42, v42
  v_exp_f32 v43, v43
  v_cvt_pk_bf16_f32 v132, v40, v41
  v_mfma_f32_32x32x16_bf16 v[112:127], a[188:191], v[140:143], v[112:127]
  v_exp_f32 v44, v44
  v_exp_f32 v45, v45
  v_cvt_pk_bf16_f32 v133, v42, v43
  v_exp_f32 v46, v46
  v_exp_f32 v47, v47
  v_cvt_pk_bf16_f32 v134, v44, v45
  v_cvt_pk_bf16_f32 v135, v46, v47
  v_mfma_f32_32x32x16_bf16 v[32:47], a[152:155], a[72:75], v[200:215]
  v_exp_f32 v48, v48
  v_exp_f32 v49, v49
  v_exp_f32 v50, v50
  v_exp_f32 v51, v51
  v_cvt_pk_bf16_f32 v136, v48, v49
  v_mfma_f32_32x32x16_bf16 v[112:127], a[176:179], v[128:131], v[112:127]
  v_exp_f32 v52, v52
  v_exp_f32 v53, v53
  v_cvt_pk_bf16_f32 v137, v50, v51
  v_exp_f32 v54, v54
  v_exp_f32 v55, v55
  v_cvt_pk_bf16_f32 v138, v52, v53
  v_cvt_pk_bf16_f32 v27, -v32, 0
  v_exp_f32 v56, v56
  v_exp_f32 v57, v57
  v_cndmask_b32 v173, 0, v27, s[64:65]
  v_cvt_pk_bf16_f32 v139, v54, v55
  s_nop 0
  v_mfma_f32_32x32x8_bf16 v[32:47], a[164:165], v[172:173], v[32:47]
  v_exp_f32 v58, v58
  v_exp_f32 v59, v59
  v_cvt_pk_bf16_f32 v140, v56, v57
  v_exp_f32 v60, v60
  v_exp_f32 v61, v61
  v_cvt_pk_bf16_f32 v141, v58, v59
  v_mfma_f32_32x32x16_bf16 v[112:127], a[180:183], v[132:135], v[112:127]
  v_exp_f32 v62, v62
  v_exp_f32 v63, v63
  v_cvt_pk_bf16_f32 v142, v60, v61
  v_cvt_pk_bf16_f32 v143, v62, v63
  s_waitcnt vmcnt(0)
  v_cmp_ne_u64 vcc, v[236:237], v[232:233]
  s_nop 0
  s_cbranch_vccnz L_vs_1
L_vr_2:
  v_mfma_f32_32x32x16_bf16 v[48:63], a[148:151], a[72:75], 0
  buffer_load_dwordx4 a[212:215], v19, s[40:43], 0 offen offset:3072 sc1
  v_exp_f32 v32, v32
  v_exp_f32 v33, v33
  v_exp_f32 v34, v34
  v_exp_f32 v35, v35
  v_cvt_pk_bf16_f32 v128, v32, v33
  v_mfma_f32_32x32x8_bf16 v[48:63], a[162:163], v[172:173], v[48:63]
  buffer_load_dword a222, v20, s[40:43], 0 offen offset:3072 sc1
  v_exp_f32 v36, v36
  v_exp_f32 v37, v37
  v_cvt_pk_bf16_f32 v129, v34, v35
  v_exp_f32 v38, v38
  v_exp_f32 v39, v39
  v_cvt_pk_bf16_f32 v130, v36, v37
  v_mfma_f32_32x32x16_bf16 v[112:127], a[168:171], v[136:139], v[112:127]
  v_exp_f32 v40, v40
  v_exp_f32 v41, v41
  v_cvt_pk_bf16_f32 v131, v38, v39
  v_exp_f32 v42, v42
  v_exp_f32 v43, v43
  v_cvt_pk_bf16_f32 v132, v40, v41
  v_mfma_f32_32x32x16_bf16 v[112:127], a[172:175], v[140:143], v[112:127]
  v_exp_f32 v44, v44
  v_exp_f32 v45, v45
  v_cvt_pk_bf16_f32 v133, v42, v43
  v_exp_f32 v46, v46
  v_exp_f32 v47, v47
  v_cvt_pk_bf16_f32 v134, v44, v45
  v_cvt_pk_bf16_f32 v135, v46, v47
  v_mfma_f32_32x32x16_bf16 v[32:47], a[144:147], a[72:75], 0
  buffer_load_dwordx4 a[208:211], v19, s[40:43], 0 offen offset:2048 sc1
  v_exp_f32 v48, v48
  v_exp_f32 v49, v49
  v_exp_f32 v50, v50
  v_exp_f32 v51, v51
  v_cvt_pk_bf16_f32 v136, v48, v49
  v_mfma_f32_32x32x8_bf16 v[32:47], a[160:161], v[172:173], v[32:47]
  buffer_load_dword a220, v20, s[40:43], 0 offen offset:2048 sc1
  v_exp_f32 v52, v52
  v_exp_f32 v53, v53
  v_cvt_pk_bf16_f32 v137, v50, v51
  v_exp_f32 v54, v54
  v_exp_f32 v55, v55
  v_cvt_pk_bf16_f32 v138, v52, v53
  v_mfma_f32_32x32x16_bf16 v[96:111], a[184:187], v[128:131], 0
  buffer_load_dwordx4 a[204:207], v19, s[40:43], 0 offen offset:1024 sc1
  v_exp_f32 v56, v56
  v_exp_f32 v57, v57
  v_cvt_pk_bf16_f32 v139, v54, v55
  v_exp_f32 v58, v58
  v_exp_f32 v59, v59
  v_cvt_pk_bf16_f32 v140, v56, v57
  v_mfma_f32_32x32x16_bf16 v[96:111], a[188:191], v[132:135], v[96:111]
  v_exp_f32 v60, v60
  v_exp_f32 v61, v61
  v_cvt_pk_bf16_f32 v141, v58, v59
  v_exp_f32 v62, v62
  v_exp_f32 v63, v63
  v_cvt_pk_bf16_f32 v142, v60, v61
  v_cvt_pk_bf16_f32 v143, v62, v63
  v_mfma_f32_32x32x16_bf16 v[48:63], a[148:151], a[68:71], v[200:215]
  buffer_load_dword a218, v20, s[40:43], 0 offen offset:1024 sc1
  v_exp_f32 v32, v32
  v_exp_f32 v33, v33
  v_exp_f32 v34, v34
  v_exp_f32 v35, v35
  v_cvt_pk_bf16_f32 v128, v32, v33
  v_mfma_f32_32x32x16_bf16 v[96:111], a[176:179], v[136:139], v[96:111]
  buffer_load_dwordx4 a[200:203], v19, s[40:43], 0 offen offset:0 sc1
  v_exp_f32 v36, v36
  v_exp_f32 v37, v37
  v_cvt_pk_bf16_f32 v129, v34, v35
  v_exp_f32 v38, v38
  v_exp_f32 v39, v39
  v_cvt_pk_bf16_f32 v130, v36, v37
  v_cvt_pk_bf16_f32 v27, -v48, 0
  v_exp_f32 v40, v40
  v_exp_f32 v41, v41
  v_cndmask_b32 v171, 0, v27, s[64:65]
  v_cvt_pk_bf16_f32 v131, v38, v39
  s_nop 0
  v_mfma_f32_32x32x8_bf16 v[48:63], a[162:163], v[170:171], v[48:63]
  v_exp_f32 v42, v42
  v_exp_f32 v43, v43
  v_cvt_pk_bf16_f32 v132, v40, v41
  v_exp_f32 v44, v44
  v_exp_f32 v45, v45
  v_cvt_pk_bf16_f32 v133, v42, v43
  v_mfma_f32_32x32x16_bf16 v[96:111], a[180:183], v[140:143], v[96:111]
  v_exp_f32 v46, v46
  v_exp_f32 v47, v47
  v_cvt_pk_bf16_f32 v134, v44, v45
  v_cvt_pk_bf16_f32 v135, v46, v47
  v_mfma_f32_32x32x16_bf16 v[32:47], a[144:147], a[68:71], 0
  buffer_load_dword a216, v20, s[40:43], 0 offen offset:0 sc1
  v_exp_f32 v48, v48
  v_exp_f32 v49, v49
  v_exp_f32 v50, v50
  v_exp_f32 v51, v51
  v_cvt_pk_bf16_f32 v136, v48, v49
  v_mfma_f32_32x32x8_bf16 v[32:47], a[160:161], v[170:171], v[32:47]
  buffer_load_dwordx4 a[24:27], v21, s[40:43], 0 offen offset:3072 sc1
  v_exp_f32 v52, v52
  v_exp_f32 v53, v53
  v_cvt_pk_bf16_f32 v137, v50, v51
  v_exp_f32 v54, v54
  v_exp_f32 v55, v55
  v_cvt_pk_bf16_f32 v138, v52, v53
  v_mfma_f32_32x32x16_bf16 v[96:111], a[168:171], v[128:131], v[96:111]
  buffer_load_dwordx4 a[28:31], v21, s[40:43], 0 offen offset:3584 sc1
  v_exp_f32 v56, v56
  v_exp_f32 v57, v57
  v_cvt_pk_bf16_f32 v139, v54, v55
  v_exp_f32 v58, v58
  v_exp_f32 v59, v59
  v_cvt_pk_bf16_f32 v140, v56, v57
  v_mfma_f32_32x32x16_bf16 v[96:111], a[172:175], v[132:135], v[96:111]
  v_exp_f32 v60, v60
  v_exp_f32 v61, v61
  v_cvt_pk_bf16_f32 v141, v58, v59
  v_exp_f32 v62, v62
  v_exp_f32 v63, v63
  v_cvt_pk_bf16_f32 v142, v60, v61
  v_cvt_pk_bf16_f32 v143, v62, v63
  v_mfma_f32_32x32x16_bf16 v[48:63], a[144:147], a[64:67], v[200:215]
  buffer_load_dwordx4 a[236:239], v19, s[4:7], 0 offen offset:3072 sc1
  v_exp_f32 v32, v32
  v_exp_f32 v33, v33
  v_exp_f32 v34, v34
  v_exp_f32 v35, v35
  v_cvt_pk_bf16_f32 v128, v32, v33
  v_mfma_f32_32x32x16_bf16 v[80:95], a[176:179], v[136:139], 0
  buffer_load_dword a246, v20, s[4:7], 0 offen offset:3072 sc1
  v_exp_f32 v36, v36
  v_exp_f32 v37, v37
  v_cvt_pk_bf16_f32 v129, v34, v35
  v_exp_f32 v38, v38
  v_exp_f32 v39, v39
  v_cvt_pk_bf16_f32 v130, v36, v37
  v_cvt_pk_bf16_f32 v27, -v48, 0
  v_exp_f32 v40, v40
  v_exp_f32 v41, v41
  v_cndmask_b32 v169, 0, v27, s[64:65]
  v_cvt_pk_bf16_f32 v131, v38, v39
  s_nop 0
  v_mfma_f32_32x32x8_bf16 v[48:63], a[160:161], v[168:169], v[48:63]
  v_exp_f32 v42, v42
  v_exp_f32 v43, v43
  v_cvt_pk_bf16_f32 v132, v40, v41
  v_exp_f32 v44, v44
  v_exp_f32 v45, v45
  v_cvt_pk_bf16_f32 v133, v42, v43
  v_mfma_f32_32x32x16_bf16 v[80:95], a[180:183], v[140:143], v[80:95]
  v_exp_f32 v46, v46
  v_exp_f32 v47, v47
  v_cvt_pk_bf16_f32 v134, v44, v45
  v_cvt_pk_bf16_f32 v135, v46, v47
  s_waitcnt vmcnt(11)
  v_mfma_f32_32x32x16_bf16 v[32:47], a[212:215], a[76:79], 0
  buffer_load_dwordx4 a[16:19], v21, s[40:43], 0 offen offset:2048 sc1
  v_exp_f32 v48, v48
  v_exp_f32 v49, v49
  v_exp_f32 v50, v50
  v_exp_f32 v51, v51
  v_cvt_pk_bf16_f32 v136, v48, v49
  s_waitcnt vmcnt(11)
  v_mfma_f32_32x32x8_bf16 v[32:47], a[222:223], v[174:175], v[32:47]
  buffer_load_dwordx4 a[20:23], v21, s[40:43], 0 offen offset:2560 sc1
  v_exp_f32 v52, v52
  v_exp_f32 v53, v53
  v_cvt_pk_bf16_f32 v137, v50, v51
  v_exp_f32 v54, v54
  v_exp_f32 v55, v55
  v_cvt_pk_bf16_f32 v138, v52, v53
  v_mfma_f32_32x32x16_bf16 v[80:95], a[168:171], v[128:131], v[80:95]
  buffer_load_dwordx4 a[232:235], v19, s[4:7], 0 offen offset:2048 sc1
  v_exp_f32 v56, v56
  v_exp_f32 v57, v57
  v_cvt_pk_bf16_f32 v139, v54, v55
  v_exp_f32 v58, v58
  v_exp_f32 v59, v59
  v_cvt_pk_bf16_f32 v140, v56, v57
  v_mfma_f32_32x32x16_bf16 v[80:95], a[172:175], v[132:135], v[80:95]
  v_exp_f32 v60, v60
  v_exp_f32 v61, v61
  v_cvt_pk_bf16_f32 v141, v58, v59
  v_exp_f32 v62, v62
  v_exp_f32 v63, v63
  v_cvt_pk_bf16_f32 v142, v60, v61
  v_cvt_pk_bf16_f32 v143, v62, v63
  s_waitcnt vmcnt(12)
  v_mfma_f32_32x32x16_bf16 v[48:63], a[208:211], a[76:79], 0
  buffer_load_dword a244, v20, s[4:7], 0 offen offset:2048 sc1
  v_exp_f32 v32, v32
  v_exp_f32 v33, v33
  v_exp_f32 v34, v34
  v_exp_f32 v35, v35
  v_cvt_pk_bf16_f32 v128, v32, v33
  s_waitcnt vmcnt(12)
  v_mfma_f32_32x32x8_bf16 v[48:63], a[220:221], v[174:175], v[48:63]
  buffer_load_dwordx4 a[8:11], v21, s[40:43], 0 offen offset:1024 sc1
  v_exp_f32 v36, v36
  v_exp_f32 v37, v37
  v_cvt_pk_bf16_f32 v129, v34, v35
  v_exp_f32 v38, v38
  v_exp_f32 v39, v39
  v_cvt_pk_bf16_f32 v130, v36, v37
  v_mfma_f32_32x32x16_bf16 v[64:79], a[168:171], v[136:139], 0
  v_exp_f32 v40, v40
  v_exp_f32 v41, v41
  v_cvt_pk_bf16_f32 v131, v38, v39
  v_exp_f32 v42, v42
  v_exp_f32 v43, v43
  v_cvt_pk_bf16_f32 v132, v40, v41
  v_mfma_f32_32x32x16_bf16 v[64:79], a[172:175], v[140:143], v[64:79]
  v_exp_f32 v44, v44
  v_exp_f32 v45, v45
  v_cvt_pk_bf16_f32 v133, v42, v43
  v_exp_f32 v46, v46
  v_exp_f32 v47, v47
  v_cvt_pk_bf16_f32 v134, v44, v45
  v_cvt_pk_bf16_f32 v135, v46, v47
  s_waitcnt vmcnt(12)
  v_mfma_f32_32x32x16_bf16 v[32:47], a[204:207], a[76:79], 0
  buffer_load_dwordx4 a[12:15], v21, s[40:43], 0 offen offset:1536 sc1
  buffer_load_dwordx4 a[228:231], v19, s[4:7], 0 offen offset:1024 sc1
  v_exp_f32 v48, v48
  v_exp_f32 v49, v49
  v_exp_f32 v50, v50
  v_exp_f32 v51, v51
  v_cvt_pk_bf16_f32 v136, v48, v49
  v_exp_f32 v52, v52
  v_exp_f32 v53, v53
  v_cvt_pk_bf16_f32 v137, v50, v51
  v_exp_f32 v54, v54
  v_exp_f32 v55, v55
  v_cvt_pk_bf16_f32 v138, v52, v53
  s_waitcnt vmcnt(13)
  v_mfma_f32_32x32x8_bf16 v[32:47], a[218:219], v[174:175], v[32:47]
  buffer_load_dword a242, v20, s[4:7], 0 offen offset:1024 sc1
  v_exp_f32 v56, v56
  v_exp_f32 v57, v57
  v_cvt_pk_bf16_f32 v139, v54, v55
  v_exp_f32 v58, v58
  v_exp_f32 v59, v59
  v_cvt_pk_bf16_f32 v140, v56, v57
  v_exp_f32 v60, v60
  v_exp_f32 v61, v61
  v_cvt_pk_bf16_f32 v141, v58, v59
  v_exp_f32 v62, v62
  v_exp_f32 v63, v63
  v_cvt_pk_bf16_f32 v142, v60, v61
  v_cvt_pk_bf16_f32 v143, v62, v63
  s_waitcnt vmcnt(13)
  v_mfma_f32_32x32x16_bf16 v[48:63], a[200:203], a[76:79], 0
  buffer_load_dwordx4 a[0:3], v21, s[40:43], 0 offen offset:0 sc1
  v_exp_f32 v32, v32
  v_exp_f32 v33, v33
  v_exp_f32 v34, v34
  v_exp_f32 v35, v35
  v_cvt_pk_bf16_f32 v144, v32, v33
  v_exp_f32 v36, v36
  v_exp_f32 v37, v37
  v_cvt_pk_bf16_f32 v145, v34, v35
  v_exp_f32 v38, v38
  v_exp_f32 v39, v39
  v_cvt_pk_bf16_f32 v146, v36, v37
  s_waitcnt vmcnt(13)
  v_mfma_f32_32x32x8_bf16 v[48:63], a[216:217], v[174:175], v[48:63]
  buffer_load_dwordx4 a[4:7], v21, s[40:43], 0 offen offset:512 sc1
  v_exp_f32 v40, v40
  v_exp_f32 v41, v41
  v_cvt_pk_bf16_f32 v147, v38, v39
  v_exp_f32 v42, v42
  v_exp_f32 v43, v43
  v_cvt_pk_bf16_f32 v148, v40, v41
  v_exp_f32 v44, v44
  v_exp_f32 v45, v45
  v_cvt_pk_bf16_f32 v149, v42, v43
  v_exp_f32 v46, v46
  v_exp_f32 v47, v47
  v_cvt_pk_bf16_f32 v150, v44, v45
  v_cvt_pk_bf16_f32 v151, v46, v47
  s_waitcnt vmcnt(11)
  v_mfma_f32_32x32x16_bf16 v[32:47], a[236:239], a[76:79], v[184:199]
  buffer_load_dwordx4 a[224:227], v19, s[4:7], 0 offen offset:0 sc1
  v_exp_f32 v48, v48
  v_exp_f32 v49, v49
  s_waitcnt vmcnt(11)
  v_mfma_f32_32x32x8_bf16 v[32:47], a[246:247], v[174:175], v[32:47]
  buffer_load_dword a240, v20, s[4:7], 0 offen offset:0 sc1
  v_exp_f32 v50, v50
  v_exp_f32 v51, v51
  v_cvt_pk_bf16_f32 v152, v48, v49
  v_mfma_f32_32x32x16_bf16 v[112:127], a[24:27], v[128:131], v[112:127]
  v_exp_f32 v52, v52
  v_exp_f32 v53, v53
  v_cvt_pk_bf16_f32 v153, v50, v51
  v_exp_f32 v54, v54
  v_exp_f32 v55, v55
  v_cvt_pk_bf16_f32 v154, v52, v53
  v_mfma_f32_32x32x16_bf16 v[112:127], a[28:31], v[132:135], v[112:127]
  v_exp_f32 v56, v56
  v_exp_f32 v57, v57
  v_cvt_pk_bf16_f32 v155, v54, v55
  s_waitcnt vmcnt(11)
  v_mfma_f32_32x32x16_bf16 v[112:127], a[16:19], v[136:139], v[112:127]
  v_exp_f32 v58, v58
  v_exp_f32 v59, v59
  v_cvt_pk_bf16_f32 v156, v56, v57
  s_waitcnt vmcnt(10)
  v_mfma_f32_32x32x16_bf16 v[112:127], a[20:23], v[140:143], v[112:127]
  v_exp_f32 v60, v60
  v_exp_f32 v61, v61
  v_cvt_pk_bf16_f32 v157, v58, v59
  v_exp_f32 v62, v62
  v_exp_f32 v63, v63
  v_cvt_pk_bf16_f32 v158, v60, v61
  v_cvt_pk_bf16_f32 v159, v62, v63
  v_mfma_f32_32x32x16_bf16 v[48:63], a[212:215], a[72:75], 0
  buffer_load_dwordx4 a[56:59], v21, s[4:7], 0 offen offset:3072 sc1
  v_exp_f32 v32, v32
  v_exp_f32 v33, v33
  v_mfma_f32_32x32x8_bf16 v[48:63], a[222:223], v[172:173], v[48:63]
  buffer_load_dwordx4 a[60:63], v21, s[4:7], 0 offen offset:3584 sc1
  v_exp_f32 v34, v34
  v_exp_f32 v35, v35
  v_cvt_pk_bf16_f32 v128, v32, v33
  s_waitcnt vmcnt(9)
  v_mfma_f32_32x32x16_bf16 v[112:127], a[8:11], v[144:147], v[112:127]
  s_add_u32 s60, s49, s26
  v_exp_f32 v36, v36
  v_exp_f32 v37, v37
  v_cvt_pk_bf16_f32 v129, v34, v35
  v_exp_f32 v38, v38
  v_exp_f32 v39, v39
  v_cvt_pk_bf16_f32 v130, v36, v37
  s_waitcnt vmcnt(8)
  v_mfma_f32_32x32x16_bf16 v[112:127], a[12:15], v[148:151], v[112:127]
  s_addc_u32 s61, s57, 0
  v_exp_f32 v40, v40
  v_exp_f32 v41, v41
  v_cvt_pk_bf16_f32 v131, v38, v39
  s_waitcnt vmcnt(5)
  v_mfma_f32_32x32x16_bf16 v[112:127], a[0:3], v[152:155], v[112:127]
  s_mov_b32 m0, s32
  v_exp_f32 v42, v42
  v_exp_f32 v43, v43
  v_cvt_pk_bf16_f32 v132, v40, v41
  s_waitcnt vmcnt(4)
  v_mfma_f32_32x32x16_bf16 v[112:127], a[4:7], v[156:159], v[112:127]
  v_exp_f32 v44, v44
  v_exp_f32 v45, v45
  v_cvt_pk_bf16_f32 v133, v42, v43
  v_exp_f32 v46, v46
  v_exp_f32 v47, v47
  v_cvt_pk_bf16_f32 v134, v44, v45
  v_cvt_pk_bf16_f32 v135, v46, v47
  v_mfma_f32_32x32x16_bf16 v[32:47], a[208:211], a[72:75], 0
  global_load_lds_dwordx4 v253, s[60:61] offset:0
  v_exp_f32 v48, v48
  v_exp_f32 v49, v49
  v_exp_f32 v50, v50
  v_exp_f32 v51, v51
  v_cvt_pk_bf16_f32 v136, v48, v49
  v_mfma_f32_32x32x8_bf16 v[32:47], a[220:221], v[172:173], v[32:47]
  global_load_lds_dwordx4 v177, s[60:61] offset:1024
  v_exp_f32 v52, v52
  v_exp_f32 v53, v53
  v_cvt_pk_bf16_f32 v137, v50, v51
  v_exp_f32 v54, v54
  v_exp_f32 v55, v55
L_pad_4:
  s_cbranch_execz L_pad_ret
  v_cvt_pk_bf16_f32 v138, v52, v53
  s_waitcnt vmcnt(3)
  v_mfma_f32_32x32x16_bf16 v[112:127], a[56:59], v[128:131], v[112:127]
  global_load_lds_dwordx4 v178, s[60:61] offset:2048
  v_exp_f32 v56, v56
  v_exp_f32 v57, v57
  v_cvt_pk_bf16_f32 v139, v54, v55
  v_exp_f32 v58, v58
  v_exp_f32 v59, v59
  v_cvt_pk_bf16_f32 v140, v56, v57
  s_waitcnt vmcnt(3)
  v_mfma_f32_32x32x16_bf16 v[112:127], a[60:63], v[132:135], v[112:127]
  v_exp_f32 v60, v60
  v_exp_f32 v61, v61
  v_cvt_pk_bf16_f32 v141, v58, v59
  v_exp_f32 v62, v62
  v_exp_f32 v63, v63
  v_cvt_pk_bf16_f32 v142, v60, v61
  v_cvt_pk_bf16_f32 v143, v62, v63
  v_mfma_f32_32x32x16_bf16 v[48:63], a[204:207], a[72:75], 0
  global_load_lds_dwordx4 v179, s[60:61] offset:3072
  s_add_u32 m0, m0, 4096
  v_exp_f32 v32, v32
  v_exp_f32 v33, v33
  v_exp_f32 v34, v34
  v_exp_f32 v35, v35
  v_cvt_pk_bf16_f32 v128, v32, v33
  v_mfma_f32_32x32x8_bf16 v[48:63], a[218:219], v[172:173], v[48:63]
  s_add_u32 s60, s60, 36864
  v_exp_f32 v36, v36
  v_exp_f32 v37, v37
  v_cvt_pk_bf16_f32 v129, v34, v35
  v_exp_f32 v38, v38
  v_exp_f32 v39, v39
  v_cvt_pk_bf16_f32 v130, v36, v37
  v_mfma_f32_32x32x16_bf16 v[96:111], a[24:27], v[136:139], v[96:111]
  s_addc_u32 s61, s61, 0
  v_exp_f32 v40, v40
  v_exp_f32 v41, v41
  v_cvt_pk_bf16_f32 v131, v38, v39
  v_exp_f32 v42, v42
  v_exp_f32 v43, v43
  v_cvt_pk_bf16_f32 v132, v40, v41
  v_mfma_f32_32x32x16_bf16 v[96:111], a[28:31], v[140:143], v[96:111]
  buffer_load_dwordx4 a[48:51], v21, s[4:7], 0 offen offset:2048 sc1
  v_exp_f32 v44, v44
  v_exp_f32 v45, v45
  v_cvt_pk_bf16_f32 v133, v42, v43
  v_exp_f32 v46, v46
  v_exp_f32 v47, v47
  v_cvt_pk_bf16_f32 v134, v44, v45
  v_cvt_pk_bf16_f32 v135, v46, v47
  v_rcp_f32 v26, v124
  v_maximum3_f32 v28, |v112|, |v113|, |v114|
  v_maximum3_f32 v29, |v115|, |v116|, |v117|
  v_maximum3_f32 v28, |v118|, |v119|, v28
  v_maximum3_f32 v29, |v120|, |v121|, v29
  v_maximum3_f32 v28, v124, v26, v28
  v_maximum3_f32 v28, v28, v29, v29
  s_add_u32 s35, s68, 221184
  v_cmp_ngt_f32 vcc, s25, v28
  s_add_u32 s38, s69, 221184
  s_cbranch_vccnz L_fb_3
L_fbret_3:
  v_mul_f32 v26, v26, v245
  v_mul_f32 v112, v26, v112
  v_mul_f32 v113, v26, v113
  v_mul_f32 v114, v26, v114
  v_mul_f32 v115, v26, v115
  v_mul_f32 v116, v26, v116
  v_mul_f32 v117, v26, v117
  v_mul_f32 v118, v26, v118
  v_mul_f32 v119, v26, v119
  v_mul_f32 v120, v26, v120
  v_mul_f32 v121, v26, v121
  v_cvt_pk_bf16_f32 v248, v112, v113
  v_cvt_pk_bf16_f32 v249, v114, v115
  v_cvt_pk_bf16_f32 v250, v116, v117
  v_cvt_pk_bf16_f32 v251, v118, v119
  v_cvt_pk_bf16_f32 v252, v120, v121
  v_mfma_f32_32x32x16_bf16 v[32:47], a[200:203], a[72:75], 0
  buffer_store_dwordx4 v[248:251], v24, s[12:15], s35 offen sc1
  v_exp_f32 v48, v48
  v_exp_f32 v49, v49
  v_exp_f32 v50, v50
  v_exp_f32 v51, v51
  v_cvt_pk_bf16_f32 v136, v48, v49
  v_mfma_f32_32x32x8_bf16 v[32:47], a[216:217], v[172:173], v[32:47]
  buffer_store_dword v252, v25, s[12:15], s38 offen sc1
  v_exp_f32 v52, v52
  v_exp_f32 v53, v53
  v_cvt_pk_bf16_f32 v137, v50, v51
  v_exp_f32 v54, v54
  v_exp_f32 v55, v55
  v_cvt_pk_bf16_f32 v138, v52, v53
  v_mfma_f32_32x32x16_bf16 v[96:111], a[16:19], v[128:131], v[96:111]
  buffer_load_dwordx4 a[52:55], v21, s[4:7], 0 offen offset:2560 sc1
  v_exp_f32 v56, v56
  v_exp_f32 v57, v57
  v_cvt_pk_bf16_f32 v139, v54, v55
  v_exp_f32 v58, v58
  v_exp_f32 v59, v59
  v_cvt_pk_bf16_f32 v140, v56, v57
  v_mfma_f32_32x32x16_bf16 v[96:111], a[20:23], v[132:135], v[96:111]
  v_exp_f32 v60, v60
  v_exp_f32 v61, v61
  v_cvt_pk_bf16_f32 v141, v58, v59
  v_exp_f32 v62, v62
  v_exp_f32 v63, v63
  v_cvt_pk_bf16_f32 v142, v60, v61
  v_cvt_pk_bf16_f32 v143, v62, v63
  v_mfma_f32_32x32x16_bf16 v[48:63], a[236:239], a[72:75], 0
  global_load_lds_dwordx4 v253, s[60:61] offset:0
  v_exp_f32 v32, v32
  v_exp_f32 v33, v33
  v_exp_f32 v34, v34
  v_exp_f32 v35, v35
  v_cvt_pk_bf16_f32 v128, v32, v33
  v_mfma_f32_32x32x8_bf16 v[48:63], a[246:247], v[172:173], v[48:63]
  global_load_lds_dwordx4 v177, s[60:61] offset:1024
  v_exp_f32 v36, v36
  v_exp_f32 v37, v37
  v_cvt_pk_bf16_f32 v129, v34, v35
  v_exp_f32 v38, v38
  v_exp_f32 v39, v39
  v_cvt_pk_bf16_f32 v130, v36, v37
  v_mfma_f32_32x32x16_bf16 v[96:111], a[8:11], v[136:139], v[96:111]
  v_exp_f32 v40, v40
  v_exp_f32 v41, v41
  v_cvt_pk_bf16_f32 v131, v38, v39
  v_exp_f32 v42, v42
  v_exp_f32 v43, v43
  v_cvt_pk_bf16_f32 v132, v40, v41
  v_mfma_f32_32x32x16_bf16 v[96:111], a[12:15], v[140:143], v[96:111]
  v_exp_f32 v44, v44
  v_exp_f32 v45, v45
  v_cvt_pk_bf16_f32 v133, v42, v43
  v_exp_f32 v46, v46
  v_exp_f32 v47, v47
  v_cvt_pk_bf16_f32 v134, v44, v45
  v_cvt_pk_bf16_f32 v135, v46, v47
  v_mfma_f32_32x32x16_bf16 v[32:47], a[232:235], a[72:75], v[184:199]
  global_load_lds_dwordx4 v178, s[60:61] offset:2048
  global_load_lds_dwordx4 v179, s[60:61] offset:3072
  v_exp_f32 v48, v48
  v_exp_f32 v49, v49
  v_exp_f32 v50, v50
  v_exp_f32 v51, v51
  v_cvt_pk_bf16_f32 v136, v48, v49
  v_mfma_f32_32x32x8_bf16 v[32:47], a[244:245], v[172:173], v[32:47]
  s_add_u32 m0, m0, 4096
  s_add_u32 s60, s60, 36864
  v_exp_f32 v52, v52
  v_exp_f32 v53, v53
  v_cvt_pk_bf16_f32 v137, v50, v51
  v_exp_f32 v54, v54
  v_exp_f32 v55, v55
  v_cvt_pk_bf16_f32 v138, v52, v53
  v_mfma_f32_32x32x16_bf16 v[96:111], a[0:3], v[128:131], v[96:111]
  s_addc_u32 s61, s61, 0
  v_exp_f32 v56, v56
  v_exp_f32 v57, v57
  v_cvt_pk_bf16_f32 v139, v54, v55
  v_exp_f32 v58, v58
  v_exp_f32 v59, v59
  v_cvt_pk_bf16_f32 v140, v56, v57
  v_mfma_f32_32x32x16_bf16 v[96:111], a[4:7], v[132:135], v[96:111]
  buffer_load_dwordx4 a[40:43], v21, s[4:7], 0 offen offset:1024 sc1
  v_exp_f32 v60, v60
  v_exp_f32 v61, v61
  v_cvt_pk_bf16_f32 v141, v58, v59
  v_exp_f32 v62, v62
  v_exp_f32 v63, v63
  v_cvt_pk_bf16_f32 v142, v60, v61
  v_cvt_pk_bf16_f32 v143, v62, v63
  v_mfma_f32_32x32x16_bf16 v[48:63], a[212:215], a[68:71], 0
  buffer_load_dwordx4 a[44:47], v21, s[4:7], 0 offen offset:1536 sc1
  v_exp_f32 v32, v32
  v_exp_f32 v33, v33
  v_exp_f32 v34, v34
  v_exp_f32 v35, v35
  v_cvt_pk_bf16_f32 v128, v32, v33
  v_mfma_f32_32x32x8_bf16 v[48:63], a[222:223], v[170:171], v[48:63]
  global_load_lds_dwordx4 v253, s[60:61] offset:0
  v_exp_f32 v36, v36
  v_exp_f32 v37, v37
  v_cvt_pk_bf16_f32 v129, v34, v35
  v_exp_f32 v38, v38
  v_exp_f32 v39, v39
  v_cvt_pk_bf16_f32 v130, v36, v37
  v_mfma_f32_32x32x16_bf16 v[96:111], a[56:59], v[136:139], v[96:111]
  v_exp_f32 v40, v40
  v_exp_f32 v41, v41
  v_cvt_pk_bf16_f32 v131, v38, v39
  v_exp_f32 v42, v42
  v_exp_f32 v43, v43
  v_cvt_pk_bf16_f32 v132, v40, v41
  v_mfma_f32_32x32x16_bf16 v[96:111], a[60:63], v[140:143], v[96:111]
  v_exp_f32 v44, v44
  v_exp_f32 v45, v45
  v_cvt_pk_bf16_f32 v133, v42, v43
  v_exp_f32 v46, v46
  v_exp_f32 v47, v47
  v_cvt_pk_bf16_f32 v134, v44, v45
  v_cvt_pk_bf16_f32 v135, v46, v47
  v_mfma_f32_32x32x16_bf16 v[32:47], a[208:211], a[68:71], 0
  global_load_lds_dwordx4 v177, s[60:61] offset:1024
  global_load_lds_dwordx4 v178, s[60:61] offset:2048
  global_load_lds_dwordx4 v179, s[60:61] offset:3072
  v_exp_f32 v48, v48
  v_exp_f32 v49, v49
  v_exp_f32 v50, v50
  v_exp_f32 v51, v51
  v_cvt_pk_bf16_f32 v136, v48, v49
  v_mfma_f32_32x32x8_bf16 v[32:47], a[220:221], v[170:171], v[32:47]
  s_add_u32 m0, m0, 4096
  s_add_u32 s60, s60, 36864
  s_addc_u32 s61, s61, 0
  v_exp_f32 v52, v52
  v_exp_f32 v53, v53
  v_cvt_pk_bf16_f32 v137, v50, v51
  v_exp_f32 v54, v54
  v_exp_f32 v55, v55
  v_cvt_pk_bf16_f32 v138, v52, v53
  s_waitcnt vmcnt(13)
  v_mfma_f32_32x32x16_bf16 v[96:111], a[48:51], v[128:131], v[96:111]
  s_cmp_eq_u32 m0, s36
  s_cselect_b32 m0, s51, m0
  v_exp_f32 v56, v56
  v_exp_f32 v57, v57
  v_cvt_pk_bf16_f32 v139, v54, v55
  v_exp_f32 v58, v58
  v_exp_f32 v59, v59
  v_cvt_pk_bf16_f32 v140, v56, v57
  s_waitcnt vmcnt(10)
  v_mfma_f32_32x32x16_bf16 v[96:111], a[52:55], v[132:135], v[96:111]
  s_cselect_b32 s60, s49, s60
  s_cselect_b32 s61, s57, s61
  v_exp_f32 v60, v60
  v_exp_f32 v61, v61
  v_cvt_pk_bf16_f32 v141, v58, v59
  v_exp_f32 v62, v62
  v_exp_f32 v63, v63
  v_cvt_pk_bf16_f32 v142, v60, v61
  v_cvt_pk_bf16_f32 v143, v62, v63
  v_mfma_f32_32x32x16_bf16 v[48:63], a[204:207], a[68:71], 0
  buffer_load_dwordx4 a[32:35], v21, s[4:7], 0 offen offset:0 sc1
  v_exp_f32 v32, v32
  v_exp_f32 v33, v33
  v_exp_f32 v34, v34
  v_exp_f32 v35, v35
  v_cvt_pk_bf16_f32 v128, v32, v33
  v_mfma_f32_32x32x8_bf16 v[48:63], a[218:219], v[170:171], v[48:63]
  buffer_load_dwordx4 a[36:39], v21, s[4:7], 0 offen offset:512 sc1
  v_exp_f32 v36, v36
  v_exp_f32 v37, v37
  v_cvt_pk_bf16_f32 v129, v34, v35
  v_exp_f32 v38, v38
  v_exp_f32 v39, v39
  v_cvt_pk_bf16_f32 v130, v36, v37
  v_mfma_f32_32x32x16_bf16 v[80:95], a[24:27], v[136:139], v[80:95]
  v_exp_f32 v40, v40
  v_exp_f32 v41, v41
  v_cvt_pk_bf16_f32 v131, v38, v39
  v_exp_f32 v42, v42
  v_exp_f32 v43, v43
  v_cvt_pk_bf16_f32 v132, v40, v41
  v_mfma_f32_32x32x16_bf16 v[80:95], a[28:31], v[140:143], v[80:95]
  v_exp_f32 v44, v44
  v_exp_f32 v45, v45
  v_cvt_pk_bf16_f32 v133, v42, v43
  v_exp_f32 v46, v46
  v_exp_f32 v47, v47
  v_cvt_pk_bf16_f32 v134, v44, v45
  v_cvt_pk_bf16_f32 v135, v46, v47
  v_rcp_f32 v26, v108
  v_maximum3_f32 v28, |v96|, |v97|, |v98|
  v_maximum3_f32 v29, |v99|, |v100|, |v101|
  v_maximum3_f32 v28, |v102|, |v103|, v28
  v_maximum3_f32 v29, |v104|, |v105|, v29
  v_maximum3_f32 v28, v108, v26, v28
  v_maximum3_f32 v28, v28, v29, v29
  s_add_u32 s35, s68, 147456
  v_cmp_ngt_f32 vcc, s25, v28
  s_add_u32 s38, s69, 147456
  s_cbranch_vccnz L_fb_2
L_fbret_2:
  v_mul_f32 v26, v26, v244
  v_mul_f32 v96, v26, v96
  v_mul_f32 v97, v26, v97
  v_mul_f32 v98, v26, v98
  v_mul_f32 v99, v26, v99
  v_mul_f32 v100, v26, v100
  v_mul_f32 v101, v26, v101
  v_mul_f32 v102, v26, v102
  v_mul_f32 v103, v26, v103
  v_mul_f32 v104, v26, v104
  v_mul_f32 v105, v26, v105
  v_cvt_pk_bf16_f32 v248, v96, v97
  v_cvt_pk_bf16_f32 v249, v98, v99
  v_cvt_pk_bf16_f32 v250, v100, v101
  v_cvt_pk_bf16_f32 v251, v102, v103
  v_cvt_pk_bf16_f32 v252, v104, v105
  v_mfma_f32_32x32x16_bf16 v[32:47], a[200:203], a[68:71], 0
  buffer_store_dwordx4 v[248:251], v24, s[12:15], s35 offen sc1
  v_exp_f32 v48, v48
  v_exp_f32 v49, v49
  v_exp_f32 v50, v50
  v_exp_f32 v51, v51
  v_cvt_pk_bf16_f32 v136, v48, v49
  v_mfma_f32_32x32x8_bf16 v[32:47], a[216:217], v[170:171], v[32:47]
  buffer_store_dword v252, v25, s[12:15], s38 offen sc1
  v_exp_f32 v52, v52
  v_exp_f32 v53, v53
  v_cvt_pk_bf16_f32 v137, v50, v51
  v_exp_f32 v54, v54
  v_exp_f32 v55, v55
  v_cvt_pk_bf16_f32 v138, v52, v53
  v_mfma_f32_32x32x16_bf16 v[80:95], a[16:19], v[128:131], v[80:95]
  global_load_lds_dwordx4 v253, s[60:61] offset:0
  v_exp_f32 v56, v56
  v_exp_f32 v57, v57
  v_cvt_pk_bf16_f32 v139, v54, v55
  v_exp_f32 v58, v58
  v_exp_f32 v59, v59
  v_cvt_pk_bf16_f32 v140, v56, v57
  v_mfma_f32_32x32x16_bf16 v[80:95], a[20:23], v[132:135], v[80:95]
  v_exp_f32 v60, v60
  v_exp_f32 v61, v61
  v_cvt_pk_bf16_f32 v141, v58, v59
  v_exp_f32 v62, v62
  v_exp_f32 v63, v63
  v_cvt_pk_bf16_f32 v142, v60, v61
  v_cvt_pk_bf16_f32 v143, v62, v63
  v_mfma_f32_32x32x16_bf16 v[48:63], a[236:239], a[68:71], 0
  global_load_lds_dwordx4 v177, s[60:61] offset:1024
  v_exp_f32 v32, v32
  v_exp_f32 v33, v33
  v_exp_f32 v34, v34
  v_exp_f32 v35, v35
  v_cvt_pk_bf16_f32 v128, v32, v33
  v_mfma_f32_32x32x8_bf16 v[48:63], a[246:247], v[170:171], v[48:63]
  global_load_lds_dwordx4 v178, s[60:61] offset:2048
  v_exp_f32 v36, v36
  v_exp_f32 v37, v37
  v_cvt_pk_bf16_f32 v129, v34, v35
  v_exp_f32 v38, v38
  v_exp_f32 v39, v39
  v_cvt_pk_bf16_f32 v130, v36, v37
  v_mfma_f32_32x32x16_bf16 v[80:95], a[8:11], v[136:139], v[80:95]
  v_exp_f32 v40, v40
  v_exp_f32 v41, v41
  v_cvt_pk_bf16_f32 v131, v38, v39
  v_exp_f32 v42, v42
  v_exp_f32 v43, v43
  v_cvt_pk_bf16_f32 v132, v40, v41
  v_mfma_f32_32x32x16_bf16 v[80:95], a[12:15], v[140:143], v[80:95]
  v_exp_f32 v44, v44
  v_exp_f32 v45, v45
  v_cvt_pk_bf16_f32 v133, v42, v43
  v_exp_f32 v46, v46
  v_exp_f32 v47, v47
  v_cvt_pk_bf16_f32 v134, v44, v45
  v_cvt_pk_bf16_f32 v135, v46, v47
  v_mfma_f32_32x32x16_bf16 v[32:47], a[232:235], a[68:71], 0
  global_load_lds_dwordx4 v179, s[60:61] offset:3072
  s_add_u32 m0, m0, 4096
  v_exp_f32 v48, v48
  v_exp_f32 v49, v49
  v_exp_f32 v50, v50
  v_exp_f32 v51, v51
  v_cvt_pk_bf16_f32 v136, v48, v49
  v_mfma_f32_32x32x8_bf16 v[32:47], a[244:245], v[170:171], v[32:47]
  s_add_u32 s60, s60, 36864
  s_addc_u32 s61, s61, 0
  v_exp_f32 v52, v52
  v_exp_f32 v53, v53
  v_cvt_pk_bf16_f32 v137, v50, v51
  v_exp_f32 v54, v54
  v_exp_f32 v55, v55
  v_cvt_pk_bf16_f32 v138, v52, v53
  v_mfma_f32_32x32x16_bf16 v[80:95], a[0:3], v[128:131], v[80:95]
  global_load_lds_dwordx4 v253, s[60:61] offset:0
  v_exp_f32 v56, v56
  v_exp_f32 v57, v57
  v_cvt_pk_bf16_f32 v139, v54, v55
  v_exp_f32 v58, v58
  v_exp_f32 v59, v59
  v_cvt_pk_bf16_f32 v140, v56, v57
  v_mfma_f32_32x32x16_bf16 v[80:95], a[4:7], v[132:135], v[80:95]
  global_load_lds_dwordx4 v177, s[60:61] offset:1024
  v_exp_f32 v60, v60
  v_exp_f32 v61, v61
  v_cvt_pk_bf16_f32 v141, v58, v59
  v_exp_f32 v62, v62
  v_exp_f32 v63, v63
  v_cvt_pk_bf16_f32 v142, v60, v61
  v_cvt_pk_bf16_f32 v143, v62, v63
  v_mfma_f32_32x32x16_bf16 v[48:63], a[228:231], a[68:71], v[184:199]
  global_load_lds_dwordx4 v178, s[60:61] offset:2048
  global_load_lds_dwordx4 v179, s[60:61] offset:3072
  s_add_u32 m0, m0, 4096
  v_exp_f32 v32, v32
  v_exp_f32 v33, v33
  v_exp_f32 v34, v34
  v_exp_f32 v35, v35
  v_cvt_pk_bf16_f32 v128, v32, v33
  v_mfma_f32_32x32x8_bf16 v[48:63], a[242:243], v[170:171], v[48:63]
  s_add_u32 s60, s60, 36864
  s_addc_u32 s61, s61, 0
  v_exp_f32 v36, v36
  v_exp_f32 v37, v37
  v_cvt_pk_bf16_f32 v129, v34, v35
  v_exp_f32 v38, v38
  v_exp_f32 v39, v39
  v_cvt_pk_bf16_f32 v130, v36, v37
  v_mfma_f32_32x32x16_bf16 v[80:95], a[56:59], v[136:139], v[80:95]
  s_cmp_eq_u32 m0, s36
  s_cselect_b32 m0, s51, m0
  v_exp_f32 v40, v40
  v_exp_f32 v41, v41
  v_cvt_pk_bf16_f32 v131, v38, v39
  v_exp_f32 v42, v42
  v_exp_f32 v43, v43
  v_cvt_pk_bf16_f32 v132, v40, v41
  v_mfma_f32_32x32x16_bf16 v[80:95], a[60:63], v[140:143], v[80:95]
  s_cselect_b32 s60, s49, s60
  s_cselect_b32 s61, s57, s61
  v_exp_f32 v44, v44
  v_exp_f32 v45, v45
  v_cvt_pk_bf16_f32 v133, v42, v43
  v_exp_f32 v46, v46
  v_exp_f32 v47, v47
  v_cvt_pk_bf16_f32 v134, v44, v45
  v_cvt_pk_bf16_f32 v135, v46, v47
  v_mfma_f32_32x32x16_bf16 v[32:47], a[212:215], a[64:67], 0
  s_waitcnt vmcnt(8)
  s_atomic_swap_x2 s[0:1], s[12:13], s63 offset:0x80000
  v_exp_f32 v48, v48
  v_exp_f32 v49, v49
  v_exp_f32 v50, v50
  v_exp_f32 v51, v51
  v_cvt_pk_bf16_f32 v136, v48, v49
  v_mfma_f32_32x32x8_bf16 v[32:47], a[222:223], v[168:169], v[32:47]
  global_load_lds_dwordx4 v253, s[60:61] offset:0
  v_exp_f32 v52, v52
  v_exp_f32 v53, v53
  v_cvt_pk_bf16_f32 v137, v50, v51
  v_exp_f32 v54, v54
  v_exp_f32 v55, v55
  v_cvt_pk_bf16_f32 v138, v52, v53
  v_mfma_f32_32x32x16_bf16 v[80:95], a[48:51], v[128:131], v[80:95]
  global_load_lds_dwordx4 v177, s[60:61] offset:1024
  v_exp_f32 v56, v56
  v_exp_f32 v57, v57
  v_cvt_pk_bf16_f32 v139, v54, v55
  v_exp_f32 v58, v58
  v_exp_f32 v59, v59
  v_cvt_pk_bf16_f32 v140, v56, v57
  v_mfma_f32_32x32x16_bf16 v[80:95], a[52:55], v[132:135], v[80:95]
  global_load_lds_dwordx4 v178, s[60:61] offset:2048
  v_exp_f32 v60, v60
  v_exp_f32 v61, v61
  v_cvt_pk_bf16_f32 v141, v58, v59
  v_exp_f32 v62, v62
  v_exp_f32 v63, v63
  v_cvt_pk_bf16_f32 v142, v60, v61
  v_cvt_pk_bf16_f32 v143, v62, v63
  v_mfma_f32_32x32x16_bf16 v[48:63], a[208:211], a[64:67], 0
  global_load_lds_dwordx4 v179, s[60:61] offset:3072
  s_add_u32 m0, m0, 4096
  v_exp_f32 v32, v32
  v_exp_f32 v33, v33
  v_exp_f32 v34, v34
  v_exp_f32 v35, v35
  v_cvt_pk_bf16_f32 v128, v32, v33
  v_mfma_f32_32x32x8_bf16 v[48:63], a[220:221], v[168:169], v[48:63]
  s_add_u32 s60, s60, 36864
  v_exp_f32 v36, v36
  v_exp_f32 v37, v37
  v_cvt_pk_bf16_f32 v129, v34, v35
  v_exp_f32 v38, v38
  v_exp_f32 v39, v39
  v_cvt_pk_bf16_f32 v130, v36, v37
  v_mfma_f32_32x32x16_bf16 v[80:95], a[40:43], v[136:139], v[80:95]
  s_addc_u32 s61, s61, 0
  v_exp_f32 v40, v40
  v_exp_f32 v41, v41
  v_cvt_pk_bf16_f32 v131, v38, v39
  v_exp_f32 v42, v42
  v_exp_f32 v43, v43
  v_cvt_pk_bf16_f32 v132, v40, v41
  v_mfma_f32_32x32x16_bf16 v[80:95], a[44:47], v[140:143], v[80:95]
  global_load_lds_dwordx4 v253, s[60:61] offset:0
  v_exp_f32 v44, v44
  v_exp_f32 v45, v45
  v_cvt_pk_bf16_f32 v133, v42, v43
  v_exp_f32 v46, v46
  v_exp_f32 v47, v47
  v_cvt_pk_bf16_f32 v134, v44, v45
  v_cvt_pk_bf16_f32 v135, v46, v47
  v_mfma_f32_32x32x16_bf16 v[32:47], a[204:207], a[64:67], 0
  global_load_lds_dwordx4 v177, s[60:61] offset:1024
  global_load_lds_dwordx4 v178, s[60:61] offset:2048
  global_load_lds_dwordx4 v179, s[60:61] offset:3072
  v_exp_f32 v48, v48
  v_exp_f32 v49, v49
  v_exp_f32 v50, v50
  v_exp_f32 v51, v51
  v_cvt_pk_bf16_f32 v136, v48, v49
  v_mfma_f32_32x32x8_bf16 v[32:47], a[218:219], v[168:169], v[32:47]
  s_add_u32 m0, m0, 4096
  s_add_u32 s60, s60, 36864
  s_addc_u32 s61, s61, 0
  v_exp_f32 v52, v52
  v_exp_f32 v53, v53
  v_cvt_pk_bf16_f32 v137, v50, v51
  v_exp_f32 v54, v54
  v_exp_f32 v55, v55
  v_cvt_pk_bf16_f32 v138, v52, v53
  v_mfma_f32_32x32x16_bf16 v[64:79], a[24:27], v[128:131], v[64:79]
  s_cmp_eq_u32 m0, s36
  s_cselect_b32 m0, s51, m0
  v_exp_f32 v56, v56
  v_exp_f32 v57, v57
  v_cvt_pk_bf16_f32 v139, v54, v55
  v_exp_f32 v58, v58
  v_exp_f32 v59, v59
  v_cvt_pk_bf16_f32 v140, v56, v57
  v_mfma_f32_32x32x16_bf16 v[64:79], a[28:31], v[132:135], v[64:79]
  s_cselect_b32 s60, s49, s60
  s_cselect_b32 s61, s57, s61
  v_exp_f32 v60, v60
  v_exp_f32 v61, v61
  v_cvt_pk_bf16_f32 v141, v58, v59
  v_exp_f32 v62, v62
  v_exp_f32 v63, v63
  v_cvt_pk_bf16_f32 v142, v60, v61
  v_cvt_pk_bf16_f32 v143, v62, v63
  v_rcp_f32 v26, v92
  v_maximum3_f32 v28, |v80|, |v81|, |v82|
  v_maximum3_f32 v29, |v83|, |v84|, |v85|
  v_maximum3_f32 v28, |v86|, |v87|, v28
  v_maximum3_f32 v29, |v88|, |v89|, v29
  v_maximum3_f32 v28, v92, v26, v28
  v_maximum3_f32 v28, v28, v29, v29
  s_add_u32 s35, s68, 73728
  v_cmp_ngt_f32 vcc, s25, v28
  s_add_u32 s38, s69, 73728
  s_cbranch_vccnz L_fb_1
L_fbret_1:
  v_mul_f32 v26, v26, v243
  v_mul_f32 v80, v26, v80
  v_mul_f32 v81, v26, v81
  v_mul_f32 v82, v26, v82
  v_mul_f32 v83, v26, v83
  v_mul_f32 v84, v26, v84
  v_mul_f32 v85, v26, v85
  v_mul_f32 v86, v26, v86
  v_mul_f32 v87, v26, v87
  v_mul_f32 v88, v26, v88
  v_mul_f32 v89, v26, v89
  v_cvt_pk_bf16_f32 v248, v80, v81
  v_cvt_pk_bf16_f32 v249, v82, v83
  v_cvt_pk_bf16_f32 v250, v84, v85
  v_cvt_pk_bf16_f32 v251, v86, v87
  v_cvt_pk_bf16_f32 v252, v88, v89
  v_mfma_f32_32x32x16_bf16 v[48:63], a[200:203], a[64:67], 0
  buffer_store_dwordx4 v[248:251], v24, s[12:15], s35 offen sc1
  v_exp_f32 v32, v32
  v_exp_f32 v33, v33
  v_exp_f32 v34, v34
  v_exp_f32 v35, v35
  v_cvt_pk_bf16_f32 v128, v32, v33
  v_mfma_f32_32x32x8_bf16 v[48:63], a[216:217], v[168:169], v[48:63]
  buffer_store_dword v252, v25, s[12:15], s38 offen sc1
  v_exp_f32 v36, v36
  v_exp_f32 v37, v37
  v_cvt_pk_bf16_f32 v129, v34, v35
  v_exp_f32 v38, v38
  v_exp_f32 v39, v39
  v_cvt_pk_bf16_f32 v130, v36, v37
  v_mfma_f32_32x32x16_bf16 v[64:79], a[16:19], v[136:139], v[64:79]
  v_exp_f32 v40, v40
  v_exp_f32 v41, v41
  v_cvt_pk_bf16_f32 v131, v38, v39
  v_exp_f32 v42, v42
  v_exp_f32 v43, v43
  v_cvt_pk_bf16_f32 v132, v40, v41
  v_mfma_f32_32x32x16_bf16 v[64:79], a[20:23], v[140:143], v[64:79]
  v_exp_f32 v44, v44
  v_exp_f32 v45, v45
  v_cvt_pk_bf16_f32 v133, v42, v43
  v_exp_f32 v46, v46
  v_exp_f32 v47, v47
  v_cvt_pk_bf16_f32 v134, v44, v45
  v_cvt_pk_bf16_f32 v135, v46, v47
  v_mfma_f32_32x32x16_bf16 v[32:47], a[236:239], a[64:67], 0
  global_load_lds_dwordx4 v253, s[60:61] offset:0
  v_exp_f32 v48, v48
  v_exp_f32 v49, v49
  v_exp_f32 v50, v50
  v_exp_f32 v51, v51
  v_cvt_pk_bf16_f32 v136, v48, v49
  v_mfma_f32_32x32x8_bf16 v[32:47], a[246:247], v[168:169], v[32:47]
  global_load_lds_dwordx4 v177, s[60:61] offset:1024
  v_exp_f32 v52, v52
  v_exp_f32 v53, v53
  v_cvt_pk_bf16_f32 v137, v50, v51
  v_exp_f32 v54, v54
  v_exp_f32 v55, v55
  v_cvt_pk_bf16_f32 v138, v52, v53
  v_mfma_f32_32x32x16_bf16 v[64:79], a[8:11], v[128:131], v[64:79]
  global_load_lds_dwordx4 v178, s[60:61] offset:2048
  v_exp_f32 v56, v56
  v_exp_f32 v57, v57
  v_cvt_pk_bf16_f32 v139, v54, v55
  v_exp_f32 v58, v58
  v_exp_f32 v59, v59
  v_cvt_pk_bf16_f32 v140, v56, v57
  v_mfma_f32_32x32x16_bf16 v[64:79], a[12:15], v[132:135], v[64:79]
  v_exp_f32 v60, v60
  v_exp_f32 v61, v61
  v_cvt_pk_bf16_f32 v141, v58, v59
  v_exp_f32 v62, v62
  v_exp_f32 v63, v63
  v_cvt_pk_bf16_f32 v142, v60, v61
  v_cvt_pk_bf16_f32 v143, v62, v63
  v_mfma_f32_32x32x16_bf16 v[48:63], a[232:235], a[64:67], 0
  global_load_lds_dwordx4 v179, s[60:61] offset:3072
  s_add_u32 m0, m0, 4096
  v_exp_f32 v32, v32
  v_exp_f32 v33, v33
  v_exp_f32 v34, v34
  v_exp_f32 v35, v35
  v_cvt_pk_bf16_f32 v128, v32, v33
  v_mfma_f32_32x32x8_bf16 v[48:63], a[244:245], v[168:169], v[48:63]
  s_add_u32 s60, s60, 36864
  v_exp_f32 v36, v36
  v_exp_f32 v37, v37
  v_cvt_pk_bf16_f32 v129, v34, v35
  v_exp_f32 v38, v38
  v_exp_f32 v39, v39
  v_cvt_pk_bf16_f32 v130, v36, v37
  v_mfma_f32_32x32x16_bf16 v[64:79], a[0:3], v[136:139], v[64:79]
  s_addc_u32 s61, s61, 0
  v_exp_f32 v40, v40
  v_exp_f32 v41, v41
  v_cvt_pk_bf16_f32 v131, v38, v39
  v_exp_f32 v42, v42
  v_exp_f32 v43, v43
  v_cvt_pk_bf16_f32 v132, v40, v41
  v_mfma_f32_32x32x16_bf16 v[64:79], a[4:7], v[140:143], v[64:79]
  global_load_lds_dwordx4 v253, s[60:61] offset:0
  v_exp_f32 v44, v44
  v_exp_f32 v45, v45
  v_cvt_pk_bf16_f32 v133, v42, v43
  v_exp_f32 v46, v46
  v_exp_f32 v47, v47
  v_cvt_pk_bf16_f32 v134, v44, v45
  v_cvt_pk_bf16_f32 v135, v46, v47
  v_mfma_f32_32x32x16_bf16 v[32:47], a[228:231], a[64:67], 0
  global_load_lds_dwordx4 v177, s[60:61] offset:1024
  v_exp_f32 v48, v48
  v_exp_f32 v49, v49
  v_exp_f32 v50, v50
  v_exp_f32 v51, v51
  v_cvt_pk_bf16_f32 v136, v48, v49
  v_mfma_f32_32x32x8_bf16 v[32:47], a[242:243], v[168:169], v[32:47]
  global_load_lds_dwordx4 v178, s[60:61] offset:2048
  v_exp_f32 v52, v52
  v_exp_f32 v53, v53
  v_cvt_pk_bf16_f32 v137, v50, v51
  v_exp_f32 v54, v54
  v_exp_f32 v55, v55
  v_cvt_pk_bf16_f32 v138, v52, v53
  v_mfma_f32_32x32x16_bf16 v[64:79], a[56:59], v[128:131], v[64:79]
  global_load_lds_dwordx4 v179, s[60:61] offset:3072
  v_exp_f32 v56, v56
  v_exp_f32 v57, v57
  v_cvt_pk_bf16_f32 v139, v54, v55
  v_exp_f32 v58, v58
  v_exp_f32 v59, v59
  v_cvt_pk_bf16_f32 v140, v56, v57
  v_mfma_f32_32x32x16_bf16 v[64:79], a[60:63], v[132:135], v[64:79]
  v_exp_f32 v60, v60
  v_exp_f32 v61, v61
  v_cvt_pk_bf16_f32 v141, v58, v59
  v_exp_f32 v62, v62
  v_exp_f32 v63, v63
  v_cvt_pk_bf16_f32 v142, v60, v61
  v_cvt_pk_bf16_f32 v143, v62, v63
  v_mfma_f32_32x32x16_bf16 v[48:63], a[224:227], a[64:67], v[184:199]
  s_waitcnt vmcnt(8)
  s_atomic_swap_x2 s[0:1], s[12:13], s63 offset:0x60000
  s_add_u32 s34, s84, 262144
  v_exp_f32 v32, v32
L_pad_5:
  s_cbranch_execz L_pad_ret
  v_exp_f32 v33, v33
  v_exp_f32 v34, v34
  v_exp_f32 v35, v35
  v_cvt_pk_bf16_f32 v128, v32, v33
  v_mfma_f32_32x32x8_bf16 v[48:63], a[240:241], v[168:169], v[48:63]
  buffer_load_dwordx2 v[236:237], v254, s[12:15], s34 offen sc1
  v_exp_f32 v36, v36
  v_exp_f32 v37, v37
  v_cvt_pk_bf16_f32 v129, v34, v35
  v_exp_f32 v38, v38
  v_exp_f32 v39, v39
  v_cvt_pk_bf16_f32 v130, v36, v37
  v_mfma_f32_32x32x16_bf16 v[64:79], a[48:51], v[136:139], v[64:79]
  s_add_u32 s33, s88, 262144
  v_exp_f32 v40, v40
  v_exp_f32 v41, v41
  v_cvt_pk_bf16_f32 v131, v38, v39
  v_exp_f32 v42, v42
  v_exp_f32 v43, v43
  v_cvt_pk_bf16_f32 v132, v40, v41
  v_mfma_f32_32x32x16_bf16 v[64:79], a[52:55], v[140:143], v[64:79]
  buffer_load_dwordx2 v[234:235], v254, s[12:15], s33 offen sc1
  v_exp_f32 v44, v44
  v_exp_f32 v45, v45
  v_cvt_pk_bf16_f32 v133, v42, v43
  v_exp_f32 v46, v46
  v_exp_f32 v47, v47
  v_cvt_pk_bf16_f32 v134, v44, v45
  v_cvt_pk_bf16_f32 v135, v46, v47
  v_mfma_f32_32x32x16_bf16 v[64:79], a[40:43], v[128:131], v[64:79]
  v_exp_f32 v48, v48
  v_exp_f32 v49, v49
  v_exp_f32 v50, v50
  v_exp_f32 v51, v51
  v_cvt_pk_bf16_f32 v136, v48, v49
  v_exp_f32 v52, v52
  v_exp_f32 v53, v53
  v_cvt_pk_bf16_f32 v137, v50, v51
  v_exp_f32 v54, v54
  v_exp_f32 v55, v55
  v_cvt_pk_bf16_f32 v138, v52, v53
  v_mfma_f32_32x32x16_bf16 v[64:79], a[44:47], v[132:135], v[64:79]
  v_exp_f32 v56, v56
  v_exp_f32 v57, v57
  v_cvt_pk_bf16_f32 v139, v54, v55
  v_exp_f32 v58, v58
  v_exp_f32 v59, v59
  v_cvt_pk_bf16_f32 v140, v56, v57
  v_exp_f32 v60, v60
  v_exp_f32 v61, v61
  v_cvt_pk_bf16_f32 v141, v58, v59
  v_exp_f32 v62, v62
  v_exp_f32 v63, v63
  v_cvt_pk_bf16_f32 v142, v60, v61
  v_cvt_pk_bf16_f32 v143, v62, v63
  v_mfma_f32_32x32x16_bf16 v[64:79], a[32:35], v[136:139], v[64:79]
  s_nop 0
  v_mfma_f32_32x32x16_bf16 v[64:79], a[36:39], v[140:143], v[64:79]
  s_nop 11
  v_rcp_f32 v26, v76
  v_maximum3_f32 v28, |v64|, |v65|, |v66|
  v_maximum3_f32 v29, |v67|, |v68|, |v69|
  v_maximum3_f32 v28, |v70|, |v71|, v28
  v_maximum3_f32 v29, |v72|, |v73|, v29
  v_maximum3_f32 v28, v76, v26, v28
  v_maximum3_f32 v28, v28, v29, v29
  s_add_u32 s35, s68, 0
  v_cmp_ngt_f32 vcc, s25, v28
  s_add_u32 s38, s69, 0
  s_cbranch_vccnz L_fb_0
L_fbret_0:
  v_mul_f32 v26, v26, v242
  v_pk_mul_f32 v[64:65], v[64:65], v[26:27] op_sel_hi:[1,0]
  v_pk_mul_f32 v[66:67], v[66:67], v[26:27] op_sel_hi:[1,0]
  v_pk_mul_f32 v[68:69], v[68:69], v[26:27] op_sel_hi:[1,0]
  v_pk_mul_f32 v[70:71], v[70:71], v[26:27] op_sel_hi:[1,0]
  v_pk_mul_f32 v[72:73], v[72:73], v[26:27] op_sel_hi:[1,0]
  v_cvt_pk_bf16_f32 v248, v64, v65
  v_cvt_pk_bf16_f32 v249, v66, v67
  v_cvt_pk_bf16_f32 v250, v68, v69
  v_cvt_pk_bf16_f32 v251, v70, v71
  v_cvt_pk_bf16_f32 v252, v72, v73
  buffer_store_dwordx4 v[248:251], v24, s[12:15], s35 offen sc1
  buffer_store_dword v252, v25, s[12:15], s38 offen sc1
L_p3:
  s_cmp_ge_u32 s70, 126
  s_cbranch_scc1 L_nop3
  s_waitcnt vmcnt(4)
  ds_read_b64_tr_b16 a[0:1], v2 offset:0
  ds_read_b64_tr_b16 a[2:3], v2 offset:1024
  ds_read_b64_tr_b16 a[4:5], v3 offset:0
  ds_read_b64_tr_b16 a[6:7], v3 offset:1024
  ds_read_b64_tr_b16 a[8:9], v4 offset:0
  ds_read_b64_tr_b16 a[10:11], v4 offset:1024
  ds_read_b64_tr_b16 a[12:13], v5 offset:0
  ds_read_b64_tr_b16 a[14:15], v5 offset:1024
  ds_read_b64_tr_b16 a[16:17], v4 offset:4608
  ds_read_b64_tr_b16 a[18:19], v4 offset:5632
  ds_read_b64_tr_b16 a[20:21], v5 offset:4608
  ds_read_b64_tr_b16 a[22:23], v5 offset:5632
  ds_read_b64_tr_b16 a[24:25], v2 offset:4608
  ds_read_b64_tr_b16 a[26:27], v2 offset:5632
  s_waitcnt vmcnt(3)
  v_cmp_ne_u64 vcc, v[236:237], v[232:233]
  s_nop 0
  s_cbranch_vccnz L_w1_16
L_w1r_17:
  s_waitcnt vmcnt(2)
  v_cmp_ne_u64 vcc, v[234:235], v[232:233]
  s_cmp_lt_u32 s71, 4
  s_cbranch_scc1 L_tailB
  s_cbranch_vccnz L_w5_21
L_w5r_22:
  s_add_u32 s80, s85, 221184
  s_addc_u32 s81, s86, 0
  global_load_dwordx4 a[80:83], v15, s[80:81] offset:0 sc1
  global_load_dwordx4 a[84:87], v15, s[80:81] offset:1024 sc1
  global_load_dwordx4 a[88:91], v15, s[80:81] offset:2048 sc1
  global_load_dwordx4 a[92:95], v15, s[80:81] offset:3072 sc1
  global_load_dwordx4 a[96:99], v16, s[80:81] offset:0 sc1
  global_load_dwordx4 a[100:103], v16, s[80:81] offset:1024 sc1
  global_load_dwordx4 a[104:107], v16, s[80:81] offset:2048 sc1
  global_load_dwordx4 a[108:111], v16, s[80:81] offset:3072 sc1
  global_load_dword a112, v10, s[80:81] offset:0 sc1
  global_load_dword a113, v10, s[80:81] offset:256 sc1
  global_load_dword a114, v10, s[80:81] offset:512 sc1
  global_load_dword a115, v10, s[80:81] offset:768 sc1
  ds_read_b64_tr_b16 a[28:29], v3 offset:4608
  ds_read_b64_tr_b16 a[30:31], v3 offset:5632
  ds_read_b64_tr_b16 a[32:33], v2 offset:9216
  ds_read_b64_tr_b16 a[34:35], v2 offset:10240
  ds_read_b64_tr_b16 a[36:37], v3 offset:9216
  ds_read_b64_tr_b16 a[38:39], v3 offset:10240
  ds_read_b64_tr_b16 a[40:41], v4 offset:9216
  ds_read_b64_tr_b16 a[42:43], v4 offset:10240
  ds_read_b64_tr_b16 a[44:45], v5 offset:9216
  ds_read_b64_tr_b16 a[46:47], v5 offset:10240
  ds_read_b64_tr_b16 a[48:49], v4 offset:13824
  ds_read_b64_tr_b16 a[50:51], v4 offset:14848
  ds_read_b64_tr_b16 a[52:53], v5 offset:13824
  ds_read_b64_tr_b16 a[54:55], v5 offset:14848
  ds_read_b64_tr_b16 a[56:57], v2 offset:13824
  ds_read_b64_tr_b16 a[58:59], v2 offset:14848
  ds_read_b64_tr_b16 a[60:61], v3 offset:13824
  ds_read_b64_tr_b16 a[62:63], v3 offset:14848
  ds_read_b64_tr_b16 a[64:65], v2 offset:18432
  ds_read_b64_tr_b16 a[66:67], v2 offset:19456
  ds_read_b64_tr_b16 a[68:69], v3 offset:18432
  ds_read_b64_tr_b16 a[70:71], v3 offset:19456
  ds_read_b64_tr_b16 a[72:73], v4 offset:18432
  ds_read_b64_tr_b16 a[74:75], v4 offset:19456
  ds_read_b64_tr_b16 a[76:77], v5 offset:18432
  ds_read_b64_tr_b16 a[78:79], v5 offset:19456
  ds_read_b64_tr_b16 a[188:189], v4 offset:23040
  ds_read_b64_tr_b16 a[190:191], v4 offset:24064
  ds_read_b64_tr_b16 a[192:193], v5 offset:23040
  ds_read_b64_tr_b16 a[194:195], v5 offset:24064
  ds_read_b64_tr_b16 a[196:197], v2 offset:23040
  ds_read_b64_tr_b16 a[198:199], v2 offset:24064
  ds_read_b64_tr_b16 a[200:201], v3 offset:23040
  ds_read_b64_tr_b16 a[202:203], v3 offset:24064
  ds_read_b64_tr_b16 a[204:205], v2 offset:27648
  ds_read_b64_tr_b16 a[206:207], v2 offset:28672
  s_waitcnt vmcnt(12)
  s_atomic_swap_x2 s[0:1], s[12:13], s63 offset:0x40000
  ds_read_b64_tr_b16 a[208:209], v3 offset:27648
  ds_read_b64_tr_b16 a[210:211], v3 offset:28672
  ds_read_b64_tr_b16 a[212:213], v4 offset:27648
  ds_read_b64_tr_b16 a[214:215], v4 offset:28672
  ds_read_b64_tr_b16 a[216:217], v5 offset:27648
  ds_read_b64_tr_b16 a[218:219], v5 offset:28672
  ds_read_b64_tr_b16 a[220:221], v4 offset:32256
  ds_read_b64_tr_b16 a[222:223], v4 offset:33280
  ds_read_b64_tr_b16 a[224:225], v5 offset:32256
  ds_read_b64_tr_b16 a[226:227], v5 offset:33280
  ds_read_b64_tr_b16 a[228:229], v2 offset:32256
  ds_read_b64_tr_b16 a[230:231], v2 offset:33280
  ds_read_b64_tr_b16 a[232:233], v3 offset:32256
  ds_read_b64_tr_b16 a[234:235], v3 offset:33280
  ds_read_b64_tr_b16 a[236:237], v6 offset:0
  ds_read_b64_tr_b16 a[238:239], v6 offset:18432
  ds_read_b64_tr_b16 a[240:241], v7 offset:0
  ds_read_b64_tr_b16 a[242:243], v7 offset:18432
  ds_read_b64_tr_b16 a[244:245], v8 offset:0
  ds_read_b64_tr_b16 a[246:247], v8 offset:18432
  ds_read_b64_tr_b16 a[248:249], v9 offset:0
  ds_read_b64_tr_b16 a[250:251], v9 offset:18432
  s_add_u32 s80, s85, 147456
  s_addc_u32 s81, s86, 0
  global_load_dwordx4 a[116:119], v15, s[80:81] offset:0 sc1
  global_load_dwordx4 a[120:123], v15, s[80:81] offset:1024 sc1
  global_load_dwordx4 a[124:127], v15, s[80:81] offset:2048 sc1
  global_load_dwordx4 a[128:131], v15, s[80:81] offset:3072 sc1
  global_load_dwordx4 a[132:135], v16, s[80:81] offset:0 sc1
  global_load_dwordx4 a[136:139], v16, s[80:81] offset:1024 sc1
  global_load_dwordx4 a[140:143], v16, s[80:81] offset:2048 sc1
  global_load_dwordx4 a[144:147], v16, s[80:81] offset:3072 sc1
  global_load_dword a148, v10, s[80:81] offset:0 sc1
  global_load_dword a149, v10, s[80:81] offset:256 sc1
  global_load_dword a150, v10, s[80:81] offset:512 sc1
  global_load_dword a151, v10, s[80:81] offset:768 sc1
  s_waitcnt vmcnt(23) lgkmcnt(14)
  v_mfma_f32_16x16x32_bf16 v[32:35], a[0:3], a[80:83], 0
  v_mfma_f32_16x16x32_bf16 v[36:39], a[4:7], a[80:83], 0
  v_mfma_f32_16x16x32_bf16 v[40:43], a[8:11], a[80:83], 0
  v_mfma_f32_16x16x32_bf16 v[44:47], a[12:15], a[80:83], 0
  s_waitcnt vmcnt(22)
  v_mfma_f32_16x16x32_bf16 v[32:35], a[16:19], a[84:87], v[32:35]
  v_mfma_f32_16x16x32_bf16 v[36:39], a[20:23], a[84:87], v[36:39]
  v_mfma_f32_16x16x32_bf16 v[40:43], a[24:27], a[84:87], v[40:43]
  v_mfma_f32_16x16x32_bf16 v[44:47], a[28:31], a[84:87], v[44:47]
  s_waitcnt vmcnt(21)
  v_mfma_f32_16x16x32_bf16 v[32:35], a[32:35], a[88:91], v[32:35]
  v_mfma_f32_16x16x32_bf16 v[36:39], a[36:39], a[88:91], v[36:39]
  v_mfma_f32_16x16x32_bf16 v[40:43], a[40:43], a[88:91], v[40:43]
  v_mfma_f32_16x16x32_bf16 v[44:47], a[44:47], a[88:91], v[44:47]
  s_waitcnt vmcnt(20)
  v_mfma_f32_16x16x32_bf16 v[32:35], a[48:51], a[92:95], v[32:35]
  v_mfma_f32_16x16x32_bf16 v[36:39], a[52:55], a[92:95], v[36:39]
  v_mfma_f32_16x16x32_bf16 v[40:43], a[56:59], a[92:95], v[40:43]
  v_mfma_f32_16x16x32_bf16 v[44:47], a[60:63], a[92:95], v[44:47]
  s_waitcnt vmcnt(19)
  v_mfma_f32_16x16x32_bf16 v[32:35], a[64:67], a[96:99], v[32:35]
  v_mfma_f32_16x16x32_bf16 v[36:39], a[68:71], a[96:99], v[36:39]
  v_mfma_f32_16x16x32_bf16 v[40:43], a[72:75], a[96:99], v[40:43]
  v_mfma_f32_16x16x32_bf16 v[44:47], a[76:79], a[96:99], v[44:47]
  s_waitcnt vmcnt(18)
  v_mfma_f32_16x16x32_bf16 v[32:35], a[188:191], a[100:103], v[32:35]
  s_add_u32 s37, s84, 131072
  buffer_load_dwordx2 v[182:183], v254, s[12:15], s37 offen sc1
  v_mfma_f32_16x16x32_bf16 v[36:39], a[192:195], a[100:103], v[36:39]
  buffer_load_dwordx4 a[152:155], v15, s[92:95], 0 offen offset:0 sc1
  v_mfma_f32_16x16x32_bf16 v[40:43], a[196:199], a[100:103], v[40:43]
  buffer_load_dwordx4 a[156:159], v15, s[92:95], 0 offen offset:1024 sc1
  v_mfma_f32_16x16x32_bf16 v[44:47], a[200:203], a[100:103], v[44:47]
  buffer_load_dwordx4 a[160:163], v15, s[92:95], 0 offen offset:2048 sc1
  s_waitcnt vmcnt(21)
  v_mfma_f32_16x16x32_bf16 v[32:35], a[204:207], a[104:107], v[32:35]
  buffer_load_dwordx4 a[164:167], v15, s[92:95], 0 offen offset:3072 sc1
  v_mfma_f32_16x16x32_bf16 v[36:39], a[208:211], a[104:107], v[36:39]
  buffer_load_dwordx4 a[168:171], v16, s[92:95], 0 offen offset:0 sc1
  v_mfma_f32_16x16x32_bf16 v[40:43], a[212:215], a[104:107], v[40:43]
  buffer_load_dwordx4 a[172:175], v16, s[92:95], 0 offen offset:1024 sc1
  v_mfma_f32_16x16x32_bf16 v[44:47], a[216:219], a[104:107], v[44:47]
  buffer_load_dwordx4 a[176:179], v16, s[92:95], 0 offen offset:2048 sc1
  s_waitcnt vmcnt(24)
  v_mfma_f32_16x16x32_bf16 v[32:35], a[220:223], a[108:111], v[32:35]
  s_waitcnt lgkmcnt(12)
  buffer_load_dwordx4 a[180:183], v16, s[92:95], 0 offen offset:3072 sc1
  v_mfma_f32_16x16x32_bf16 v[36:39], a[224:227], a[108:111], v[36:39]
  s_waitcnt lgkmcnt(10)
  buffer_load_dword a184, v10, s[92:95], 0 offen offset:0 sc1
  v_mfma_f32_16x16x32_bf16 v[40:43], a[228:231], a[108:111], v[40:43]
  s_waitcnt lgkmcnt(8)
  buffer_load_dword a185, v10, s[92:95], 0 offen offset:256 sc1
  v_mfma_f32_16x16x32_bf16 v[44:47], a[232:235], a[108:111], v[44:47]
  buffer_load_dword a186, v10, s[92:95], 0 offen offset:512 sc1
  s_waitcnt vmcnt(24) lgkmcnt(6)
  v_mfma_f32_16x16x32_bf16 v[32:35], a[236:239], a[112:115], v[32:35]
  s_waitcnt lgkmcnt(4)
  buffer_load_dword a187, v10, s[92:95], 0 offen offset:768 sc1
  v_mfma_f32_16x16x32_bf16 v[36:39], a[240:243], a[112:115], v[36:39]
  s_waitcnt lgkmcnt(2)
  v_mfma_f32_16x16x32_bf16 v[40:43], a[244:247], a[112:115], v[40:43]
  s_waitcnt lgkmcnt(0)
  v_mfma_f32_16x16x32_bf16 v[44:47], a[248:251], a[112:115], v[44:47]
  s_waitcnt vmcnt(24)
  v_mfma_f32_16x16x32_bf16 v[48:51], a[0:3], a[116:119], 0
  v_and_b32 v26, 15, v1
  v_mfma_f32_16x16x32_bf16 v[52:55], a[4:7], a[116:119], 0
  v_lshrrev_b32 v27, 4, v1
  v_mfma_f32_16x16x32_bf16 v[56:59], a[8:11], a[116:119], 0
  v_xor_b32 v28, v26, v27
  v_mfma_f32_16x16x32_bf16 v[60:63], a[12:15], a[116:119], 0
  v_lshlrev_b32 v28, 4, v28
  s_waitcnt vmcnt(23)
  v_mfma_f32_16x16x32_bf16 v[48:51], a[16:19], a[120:123], v[48:51]
  v_lshl_add_u32 v28, v26, 8, v28
  v_mfma_f32_16x16x32_bf16 v[52:55], a[20:23], a[120:123], v[52:55]
  v_add_u32 v11, s51, v28
  v_mfma_f32_16x16x32_bf16 v[56:59], a[24:27], a[120:123], v[56:59]
  v_xor_b32 v12, 64, v11
  v_mfma_f32_16x16x32_bf16 v[60:63], a[28:31], a[120:123], v[60:63]
  v_xor_b32 v13, 128, v11
  s_waitcnt vmcnt(22)
  v_mfma_f32_16x16x32_bf16 v[48:51], a[32:35], a[124:127], v[48:51]
  v_xor_b32 v14, 192, v11
  v_mfma_f32_16x16x32_bf16 v[52:55], a[36:39], a[124:127], v[52:55]
  s_lshl_b32 s48, s28, 2
  v_add_u32 v27, s48, v27
  v_mfma_f32_16x16x32_bf16 v[56:59], a[40:43], a[124:127], v[56:59]
  v_xor_b32 v28, v26, v27
  v_mfma_f32_16x16x32_bf16 v[60:63], a[44:47], a[124:127], v[60:63]
  s_waitcnt vmcnt(12)
  v_cmp_ne_u64 vcc, v[182:183], v[232:233]
  v_mfma_f32_16x16x32_bf16 v[48:51], a[48:51], a[128:131], v[48:51]
  s_cbranch_vccnz L_o3s_29
L_o3r_30:
  buffer_load_dwordx2 v[228:229], v254, s[12:15], s84 offen sc1
  v_mfma_f32_16x16x32_bf16 v[52:55], a[52:55], a[128:131], v[52:55]
  s_add_u32 s80, s85, 73728
  v_lshlrev_b32 v28, 4, v28
  v_mfma_f32_16x16x32_bf16 v[56:59], a[56:59], a[128:131], v[56:59]
  s_addc_u32 s81, s86, 0
  global_load_dwordx4 v[112:115], v15, s[80:81] offset:0 sc1
  v_mfma_f32_16x16x32_bf16 v[60:63], a[60:63], a[128:131], v[60:63]
  global_load_dwordx4 v[116:119], v15, s[80:81] offset:1024 sc1
  v_mfma_f32_16x16x32_bf16 v[48:51], a[64:67], a[132:135], v[48:51]
  global_load_dwordx4 v[120:123], v15, s[80:81] offset:2048 sc1
  v_mfma_f32_16x16x32_bf16 v[52:55], a[68:71], a[132:135], v[52:55]
  global_load_dwordx4 v[124:127], v15, s[80:81] offset:3072 sc1
  v_mfma_f32_16x16x32_bf16 v[56:59], a[72:75], a[132:135], v[56:59]
  global_load_dwordx4 v[128:131], v16, s[80:81] offset:0 sc1
  v_mfma_f32_16x16x32_bf16 v[60:63], a[76:79], a[132:135], v[60:63]
  global_load_dwordx4 v[132:135], v16, s[80:81] offset:1024 sc1
  v_mfma_f32_16x16x32_bf16 v[48:51], a[188:191], a[136:139], v[48:51]
  global_load_dwordx4 v[136:139], v16, s[80:81] offset:2048 sc1
  v_mfma_f32_16x16x32_bf16 v[52:55], a[192:195], a[136:139], v[52:55]
  global_load_dwordx4 v[140:143], v16, s[80:81] offset:3072 sc1
  v_mfma_f32_16x16x32_bf16 v[56:59], a[196:199], a[136:139], v[56:59]
  global_load_dword v144, v10, s[80:81] offset:0 sc1
  v_mfma_f32_16x16x32_bf16 v[60:63], a[200:203], a[136:139], v[60:63]
  global_load_dword v145, v10, s[80:81] offset:256 sc1
  v_mfma_f32_16x16x32_bf16 v[48:51], a[204:207], a[140:143], v[48:51]
  global_load_dword v146, v10, s[80:81] offset:512 sc1
  v_mfma_f32_16x16x32_bf16 v[52:55], a[208:211], a[140:143], v[52:55]
  global_load_dword v147, v10, s[80:81] offset:768 sc1
  v_mfma_f32_16x16x32_bf16 v[56:59], a[212:215], a[140:143], v[56:59]
  v_lshl_add_u32 v17, v27, 8, v28
  v_mfma_f32_16x16x32_bf16 v[60:63], a[216:219], a[140:143], v[60:63]
  v_add_u32 v18, 73728, v17
  v_mfma_f32_16x16x32_bf16 v[48:51], a[220:223], a[144:147], v[48:51]
  v_mul_u32_u24 v27, 1152, v27
  v_mfma_f32_16x16x32_bf16 v[52:55], a[224:227], a[144:147], v[52:55]
  v_lshl_add_u32 v19, v26, 3, v27
  v_mfma_f32_16x16x32_bf16 v[56:59], a[228:231], a[144:147], v[56:59]
  ds_write_b128 v11, v[32:35] offset:0
  v_mfma_f32_16x16x32_bf16 v[60:63], a[232:235], a[144:147], v[60:63]
  v_mfma_f32_16x16x32_bf16 v[48:51], a[236:239], a[148:151], v[48:51]
  v_mfma_f32_16x16x32_bf16 v[52:55], a[240:243], a[148:151], v[52:55]
  ds_write_b128 v12, v[36:39] offset:0
  v_mfma_f32_16x16x32_bf16 v[56:59], a[244:247], a[148:151], v[56:59]
  v_mfma_f32_16x16x32_bf16 v[60:63], a[248:251], a[148:151], v[60:63]
  ds_write_b128 v13, v[40:43] offset:0
  ds_write_b128 v14, v[44:47] offset:0
  s_waitcnt vmcnt(24)
  v_mfma_f32_16x16x32_bf16 v[64:67], a[0:3], a[152:155], 0
  v_mfma_f32_16x16x32_bf16 v[68:71], a[4:7], a[152:155], 0
  v_mfma_f32_16x16x32_bf16 v[72:75], a[8:11], a[152:155], 0
  v_mfma_f32_16x16x32_bf16 v[76:79], a[12:15], a[152:155], 0
  ds_write_b128 v11, v[48:51] offset:4096
  s_waitcnt vmcnt(23)
  v_mfma_f32_16x16x32_bf16 v[64:67], a[16:19], a[156:159], v[64:67]
  v_mfma_f32_16x16x32_bf16 v[68:71], a[20:23], a[156:159], v[68:71]
  v_mfma_f32_16x16x32_bf16 v[72:75], a[24:27], a[156:159], v[72:75]
  ds_write_b128 v12, v[52:55] offset:4096
  v_mfma_f32_16x16x32_bf16 v[76:79], a[28:31], a[156:159], v[76:79]
  s_waitcnt vmcnt(22)
  v_mfma_f32_16x16x32_bf16 v[64:67], a[32:35], a[160:163], v[64:67]
  v_mfma_f32_16x16x32_bf16 v[68:71], a[36:39], a[160:163], v[68:71]
  ds_write_b128 v13, v[56:59] offset:4096
  v_mfma_f32_16x16x32_bf16 v[72:75], a[40:43], a[160:163], v[72:75]
  v_mfma_f32_16x16x32_bf16 v[76:79], a[44:47], a[160:163], v[76:79]
  s_waitcnt vmcnt(21)
  v_mfma_f32_16x16x32_bf16 v[64:67], a[48:51], a[164:167], v[64:67]
  ds_write_b128 v14, v[60:63] offset:4096
  v_mfma_f32_16x16x32_bf16 v[68:71], a[52:55], a[164:167], v[68:71]
  v_mfma_f32_16x16x32_bf16 v[72:75], a[56:59], a[164:167], v[72:75]
  v_mfma_f32_16x16x32_bf16 v[76:79], a[60:63], a[164:167], v[76:79]
  s_waitcnt vmcnt(20)
  v_mfma_f32_16x16x32_bf16 v[64:67], a[64:67], a[168:171], v[64:67]
  v_mfma_f32_16x16x32_bf16 v[68:71], a[68:71], a[168:171], v[68:71]
  v_mfma_f32_16x16x32_bf16 v[72:75], a[72:75], a[168:171], v[72:75]
  v_mfma_f32_16x16x32_bf16 v[76:79], a[76:79], a[168:171], v[76:79]
  s_waitcnt vmcnt(12)
  v_cmp_ne_u64 vcc, v[228:229], v[232:233]
  v_mfma_f32_16x16x32_bf16 v[64:67], a[188:191], a[172:175], v[64:67]
  s_cbranch_vccnz L_o4s_26
L_o4r_27:
  s_add_u32 s80, s85, 0
  v_mfma_f32_16x16x32_bf16 v[68:71], a[192:195], a[172:175], v[68:71]
  s_addc_u32 s81, s86, 0
  global_load_dwordx4 v[184:187], v15, s[80:81] offset:0 sc1
  v_mfma_f32_16x16x32_bf16 v[72:75], a[196:199], a[172:175], v[72:75]
  global_load_dwordx4 v[188:191], v15, s[80:81] offset:1024 sc1
  v_mfma_f32_16x16x32_bf16 v[76:79], a[200:203], a[172:175], v[76:79]
  global_load_dwordx4 v[192:195], v15, s[80:81] offset:2048 sc1
  v_mfma_f32_16x16x32_bf16 v[64:67], a[204:207], a[176:179], v[64:67]
  global_load_dwordx4 v[196:199], v15, s[80:81] offset:3072 sc1
  v_mfma_f32_16x16x32_bf16 v[68:71], a[208:211], a[176:179], v[68:71]
  global_load_dwordx4 v[200:203], v16, s[80:81] offset:0 sc1
  v_mfma_f32_16x16x32_bf16 v[72:75], a[212:215], a[176:179], v[72:75]
  global_load_dwordx4 v[204:207], v16, s[80:81] offset:1024 sc1
  v_mfma_f32_16x16x32_bf16 v[76:79], a[216:219], a[176:179], v[76:79]
  global_load_dwordx4 v[208:211], v16, s[80:81] offset:2048 sc1
  v_mfma_f32_16x16x32_bf16 v[64:67], a[220:223], a[180:183], v[64:67]
  global_load_dwordx4 v[212:215], v16, s[80:81] offset:3072 sc1
  v_mfma_f32_16x16x32_bf16 v[68:71], a[224:227], a[180:183], v[68:71]
  global_load_dword v216, v10, s[80:81] offset:0 sc1
  v_mfma_f32_16x16x32_bf16 v[72:75], a[228:231], a[180:183], v[72:75]
  global_load_dword v217, v10, s[80:81] offset:256 sc1
  v_mfma_f32_16x16x32_bf16 v[76:79], a[232:235], a[180:183], v[76:79]
  global_load_dword v218, v10, s[80:81] offset:512 sc1
  v_mfma_f32_16x16x32_bf16 v[64:67], a[236:239], a[184:187], v[64:67]
  global_load_dword v219, v10, s[80:81] offset:768 sc1
  v_mfma_f32_16x16x32_bf16 v[68:71], a[240:243], a[184:187], v[68:71]
  v_mfma_f32_16x16x32_bf16 v[72:75], a[244:247], a[184:187], v[72:75]
  v_mfma_f32_16x16x32_bf16 v[76:79], a[248:251], a[184:187], v[76:79]
  s_nop 3
  ds_write_b128 v11, v[64:67] offset:8192
  s_nop 0
  ds_write_b128 v12, v[68:71] offset:8192
  ds_write_b128 v13, v[72:75] offset:8192
  ds_write_b128 v14, v[76:79] offset:8192
  s_waitcnt lgkmcnt(0)
  s_barrier
  ds_read_b128 v[32:35], v17 offset:0
  ds_read_b128 v[36:39], v17 offset:36864
  ds_read_b128 v[40:43], v18 offset:0
  ds_read_b128 v[44:47], v18 offset:36864
  ds_read_b128 v[48:51], v17 offset:4096
  ds_read_b128 v[52:55], v17 offset:40960
  ds_read_b128 v[56:59], v18 offset:4096
  ds_read_b128 v[60:63], v18 offset:40960
  ds_read_b128 v[64:67], v17 offset:8192
  ds_read_b128 v[68:71], v17 offset:45056
  ds_read_b128 v[72:75], v18 offset:8192
  ds_read_b128 v[76:79], v18 offset:45056
  s_waitcnt vmcnt(23)
  v_mfma_f32_16x16x32_bf16 v[80:83], a[0:3], v[112:115], 0
  s_waitcnt lgkmcnt(10)
  v_add_f32 v32, v32, v36
  v_mfma_f32_16x16x32_bf16 v[84:87], a[4:7], v[112:115], 0
  v_add_f32 v33, v33, v37
  v_mfma_f32_16x16x32_bf16 v[88:91], a[8:11], v[112:115], 0
  v_add_f32 v34, v34, v38
  v_mfma_f32_16x16x32_bf16 v[92:95], a[12:15], v[112:115], 0
  v_add_f32 v35, v35, v39
  s_waitcnt vmcnt(22)
  v_mfma_f32_16x16x32_bf16 v[80:83], a[16:19], v[116:119], v[80:83]
  s_waitcnt lgkmcnt(8)
  v_add_f32 v40, v40, v44
  v_mfma_f32_16x16x32_bf16 v[84:87], a[20:23], v[116:119], v[84:87]
  v_add_f32 v41, v41, v45
  v_mfma_f32_16x16x32_bf16 v[88:91], a[24:27], v[116:119], v[88:91]
  v_add_f32 v42, v42, v46
  v_mfma_f32_16x16x32_bf16 v[92:95], a[28:31], v[116:119], v[92:95]
  v_add_f32 v43, v43, v47
  s_waitcnt vmcnt(21)
  v_mfma_f32_16x16x32_bf16 v[80:83], a[32:35], v[120:123], v[80:83]
  v_add_f32 v32, v32, v40
  v_mfma_f32_16x16x32_bf16 v[84:87], a[36:39], v[120:123], v[84:87]
  v_add_f32 v33, v33, v41
  v_mfma_f32_16x16x32_bf16 v[88:91], a[40:43], v[120:123], v[88:91]
  v_add_f32 v34, v34, v42
  v_mfma_f32_16x16x32_bf16 v[92:95], a[44:47], v[120:123], v[92:95]
  v_add_f32 v35, v35, v43
  s_waitcnt vmcnt(20)
  v_mfma_f32_16x16x32_bf16 v[80:83], a[48:51], v[124:127], v[80:83]
  v_cvt_pk_bf16_f32 v32, v32, v33
  v_mfma_f32_16x16x32_bf16 v[84:87], a[52:55], v[124:127], v[84:87]
  v_cvt_pk_bf16_f32 v33, v34, v35
  v_mfma_f32_16x16x32_bf16 v[88:91], a[56:59], v[124:127], v[88:91]
  s_add_u32 s35, s87, 110592
  buffer_store_dwordx2 v[32:33], v19, s[20:23], s35 offen
  v_mfma_f32_16x16x32_bf16 v[92:95], a[60:63], v[124:127], v[92:95]
  s_waitcnt lgkmcnt(6)
  v_add_f32 v48, v48, v52
  s_waitcnt vmcnt(20)
  v_mfma_f32_16x16x32_bf16 v[80:83], a[64:67], v[128:131], v[80:83]
  v_add_f32 v49, v49, v53
  v_mfma_f32_16x16x32_bf16 v[84:87], a[68:71], v[128:131], v[84:87]
  v_add_f32 v50, v50, v54
  v_mfma_f32_16x16x32_bf16 v[88:91], a[72:75], v[128:131], v[88:91]
  v_add_f32 v51, v51, v55
  v_mfma_f32_16x16x32_bf16 v[92:95], a[76:79], v[128:131], v[92:95]
  s_waitcnt lgkmcnt(4)
  v_add_f32 v56, v56, v60
  s_waitcnt vmcnt(19)
  v_mfma_f32_16x16x32_bf16 v[80:83], a[188:191], v[132:135], v[80:83]
  v_add_f32 v57, v57, v61
  v_mfma_f32_16x16x32_bf16 v[84:87], a[192:195], v[132:135], v[84:87]
  v_add_f32 v58, v58, v62
  v_mfma_f32_16x16x32_bf16 v[88:91], a[196:199], v[132:135], v[88:91]
  v_add_f32 v59, v59, v63
  v_mfma_f32_16x16x32_bf16 v[92:95], a[200:203], v[132:135], v[92:95]
  v_add_f32 v48, v48, v56
  s_waitcnt vmcnt(18)
  v_mfma_f32_16x16x32_bf16 v[80:83], a[204:207], v[136:139], v[80:83]
  v_add_f32 v49, v49, v57
  v_mfma_f32_16x16x32_bf16 v[84:87], a[208:211], v[136:139], v[84:87]
  v_add_f32 v50, v50, v58
  v_mfma_f32_16x16x32_bf16 v[88:91], a[212:215], v[136:139], v[88:91]
  v_add_f32 v51, v51, v59
  v_mfma_f32_16x16x32_bf16 v[92:95], a[216:219], v[136:139], v[92:95]
  v_cvt_pk_bf16_f32 v48, v48, v49
  s_waitcnt vmcnt(17)
  v_mfma_f32_16x16x32_bf16 v[80:83], a[220:223], v[140:143], v[80:83]
  v_cvt_pk_bf16_f32 v49, v50, v51
  v_mfma_f32_16x16x32_bf16 v[84:87], a[224:227], v[140:143], v[84:87]
  s_add_u32 s35, s87, 73728
  buffer_store_dwordx2 v[48:49], v19, s[20:23], s35 offen
  v_mfma_f32_16x16x32_bf16 v[88:91], a[228:231], v[140:143], v[88:91]
  s_waitcnt lgkmcnt(2)
  v_add_f32 v64, v64, v68
  v_mfma_f32_16x16x32_bf16 v[92:95], a[232:235], v[140:143], v[92:95]
  v_add_f32 v65, v65, v69
  s_waitcnt vmcnt(14)
  v_mfma_f32_16x16x32_bf16 v[80:83], a[236:239], v[144:147], v[80:83]
  v_add_f32 v66, v66, v70
  v_mfma_f32_16x16x32_bf16 v[84:87], a[240:243], v[144:147], v[84:87]
  v_add_f32 v67, v67, v71
  v_mfma_f32_16x16x32_bf16 v[88:91], a[244:247], v[144:147], v[88:91]
  s_waitcnt lgkmcnt(0)
  v_add_f32 v72, v72, v76
  v_mfma_f32_16x16x32_bf16 v[92:95], a[248:251], v[144:147], v[92:95]
  v_add_f32 v73, v73, v77
  s_waitcnt vmcnt(13)
  v_mfma_f32_16x16x32_bf16 v[96:99], a[0:3], v[184:187], 0
  v_add_f32 v74, v74, v78
  s_waitcnt vmcnt(12)
  v_mfma_f32_16x16x32_bf16 v[96:99], a[16:19], v[188:191], v[96:99]
  v_add_f32 v75, v75, v79
  s_waitcnt vmcnt(11)
  v_mfma_f32_16x16x32_bf16 v[96:99], a[32:35], v[192:195], v[96:99]
  v_add_f32 v64, v64, v72
  s_waitcnt vmcnt(10)
  v_mfma_f32_16x16x32_bf16 v[96:99], a[48:51], v[196:199], v[96:99]
  ds_write_b128 v11, v[80:83] offset:12288
  s_waitcnt vmcnt(9)
  v_mfma_f32_16x16x32_bf16 v[96:99], a[64:67], v[200:203], v[96:99]
  v_add_f32 v65, v65, v73
  s_waitcnt vmcnt(8)
  v_mfma_f32_16x16x32_bf16 v[96:99], a[188:191], v[204:207], v[96:99]
  v_add_f32 v66, v66, v74
  s_waitcnt vmcnt(7)
  v_mfma_f32_16x16x32_bf16 v[96:99], a[204:207], v[208:211], v[96:99]
  ds_write_b128 v12, v[84:87] offset:12288
  s_waitcnt vmcnt(6)
  v_mfma_f32_16x16x32_bf16 v[96:99], a[220:223], v[212:215], v[96:99]
  v_add_f32 v67, v67, v75
  s_waitcnt vmcnt(2)
  v_mfma_f32_16x16x32_bf16 v[96:99], a[236:239], v[216:219], v[96:99]
  v_cvt_pk_bf16_f32 v64, v64, v65
  v_mfma_f32_16x16x32_bf16 v[100:103], a[4:7], v[184:187], 0
  ds_write_b128 v13, v[88:91] offset:12288
  v_mfma_f32_16x16x32_bf16 v[100:103], a[20:23], v[188:191], v[100:103]
  v_cvt_pk_bf16_f32 v65, v66, v67
  v_mfma_f32_16x16x32_bf16 v[100:103], a[36:39], v[192:195], v[100:103]
  s_add_u32 s35, s91, 0
  buffer_store_dwordx2 v[64:65], v19, s[96:99], s35 offen
  v_mfma_f32_16x16x32_bf16 v[100:103], a[52:55], v[196:199], v[100:103]
  ds_write_b128 v14, v[92:95] offset:12288
  v_mfma_f32_16x16x32_bf16 v[100:103], a[68:71], v[200:203], v[100:103]
  v_mfma_f32_16x16x32_bf16 v[100:103], a[192:195], v[204:207], v[100:103]
  ds_write_b128 v11, v[96:99] offset:16384
  v_mfma_f32_16x16x32_bf16 v[100:103], a[208:211], v[208:211], v[100:103]
  v_mfma_f32_16x16x32_bf16 v[100:103], a[224:227], v[212:215], v[100:103]
  v_mfma_f32_16x16x32_bf16 v[100:103], a[240:243], v[216:219], v[100:103]
  v_mfma_f32_16x16x32_bf16 v[104:107], a[8:11], v[184:187], 0
  v_mfma_f32_16x16x32_bf16 v[104:107], a[24:27], v[188:191], v[104:107]
  v_mfma_f32_16x16x32_bf16 v[104:107], a[40:43], v[192:195], v[104:107]
  v_mfma_f32_16x16x32_bf16 v[104:107], a[56:59], v[196:199], v[104:107]
  v_mfma_f32_16x16x32_bf16 v[104:107], a[72:75], v[200:203], v[104:107]
  v_mfma_f32_16x16x32_bf16 v[104:107], a[196:199], v[204:207], v[104:107]
  s_nop 1
  ds_write_b128 v12, v[100:103] offset:16384
  v_mfma_f32_16x16x32_bf16 v[104:107], a[212:215], v[208:211], v[104:107]
  v_mfma_f32_16x16x32_bf16 v[104:107], a[228:231], v[212:215], v[104:107]
  v_mfma_f32_16x16x32_bf16 v[104:107], a[244:247], v[216:219], v[104:107]
  v_mfma_f32_16x16x32_bf16 v[108:111], a[12:15], v[184:187], 0
  v_mfma_f32_16x16x32_bf16 v[108:111], a[28:31], v[188:191], v[108:111]
  v_mfma_f32_16x16x32_bf16 v[108:111], a[44:47], v[192:195], v[108:111]
  v_mfma_f32_16x16x32_bf16 v[108:111], a[60:63], v[196:199], v[108:111]
  v_mfma_f32_16x16x32_bf16 v[108:111], a[76:79], v[200:203], v[108:111]
  v_mfma_f32_16x16x32_bf16 v[108:111], a[200:203], v[204:207], v[108:111]
  s_nop 1
  ds_write_b128 v13, v[104:107] offset:16384
  v_mfma_f32_16x16x32_bf16 v[108:111], a[216:219], v[208:211], v[108:111]
  v_mfma_f32_16x16x32_bf16 v[108:111], a[232:235], v[212:215], v[108:111]
  v_mfma_f32_16x16x32_bf16 v[108:111], a[248:251], v[216:219], v[108:111]
  s_nop 7
  ds_write_b128 v14, v[108:111] offset:16384
  s_waitcnt lgkmcnt(0)
  s_barrier
  ds_read_b128 v[80:83], v17 offset:12288
  ds_read_b128 v[84:87], v17 offset:49152
  ds_read_b128 v[88:91], v18 offset:12288
  ds_read_b128 v[92:95], v18 offset:49152
  ds_read_b128 v[96:99], v17 offset:16384
  ds_read_b128 v[100:103], v17 offset:53248
  ds_read_b128 v[104:107], v18 offset:16384
  ds_read_b128 v[108:111], v18 offset:53248
  s_waitcnt lgkmcnt(6)
  v_pk_add_f32 v[80:81], v[80:81], v[84:85]
  v_pk_add_f32 v[82:83], v[82:83], v[86:87]
  s_waitcnt lgkmcnt(4)
  v_pk_add_f32 v[88:89], v[88:89], v[92:93]
  v_pk_add_f32 v[90:91], v[90:91], v[94:95]
  v_pk_add_f32 v[80:81], v[80:81], v[88:89]
  v_pk_add_f32 v[82:83], v[82:83], v[90:91]
L_pad_6:
  s_cbranch_execz L_pad_ret
  v_cvt_pk_bf16_f32 v80, v80, v81
  v_cvt_pk_bf16_f32 v81, v82, v83
  s_add_u32 s35, s87, 36864
  buffer_store_dwordx2 v[80:81], v19, s[20:23], s35 offen
  s_waitcnt lgkmcnt(2)
  v_pk_add_f32 v[96:97], v[96:97], v[100:101]
  v_pk_add_f32 v[98:99], v[98:99], v[102:103]
  s_waitcnt lgkmcnt(0)
  v_pk_add_f32 v[104:105], v[104:105], v[108:109]
  v_pk_add_f32 v[106:107], v[106:107], v[110:111]
  v_pk_add_f32 v[96:97], v[96:97], v[104:105]
  v_pk_add_f32 v[98:99], v[98:99], v[106:107]
  v_cvt_pk_bf16_f32 v96, v96, v97
  v_cvt_pk_bf16_f32 v97, v98, v99
  s_add_u32 s35, s87, 0
  buffer_store_dwordx2 v[96:97], v19, s[20:23], s35 offen
L_fin:
L_end:
  s_endpgm
L_tailB:
L_pad_7:
  s_cbranch_execz L_pad_ret
  s_add_u32 s80, s85, 147456
  s_addc_u32 s81, s86, 0
  global_load_dwordx4 a[116:119], v15, s[80:81] offset:0 sc1
  global_load_dwordx4 a[120:123], v15, s[80:81] offset:1024 sc1
  global_load_dwordx4 a[124:127], v15, s[80:81] offset:2048 sc1
  global_load_dwordx4 a[128:131], v15, s[80:81] offset:3072 sc1
  global_load_dwordx4 a[132:135], v16, s[80:81] offset:0 sc1
  global_load_dwordx4 a[136:139], v16, s[80:81] offset:1024 sc1
  global_load_dwordx4 a[140:143], v16, s[80:81] offset:2048 sc1
  global_load_dwordx4 a[144:147], v16, s[80:81] offset:3072 sc1
  global_load_dword a148, v10, s[80:81] offset:0 sc1
  global_load_dword a149, v10, s[80:81] offset:256 sc1
  global_load_dword a150, v10, s[80:81] offset:512 sc1
  global_load_dword a151, v10, s[80:81] offset:768 sc1
  ds_read_b64_tr_b16 a[28:29], v3 offset:4608
  ds_read_b64_tr_b16 a[30:31], v3 offset:5632
  ds_read_b64_tr_b16 a[32:33], v2 offset:9216
  ds_read_b64_tr_b16 a[34:35], v2 offset:10240
  ds_read_b64_tr_b16 a[36:37], v3 offset:9216
  ds_read_b64_tr_b16 a[38:39], v3 offset:10240
  ds_read_b64_tr_b16 a[40:41], v4 offset:9216
  ds_read_b64_tr_b16 a[42:43], v4 offset:10240
  ds_read_b64_tr_b16 a[44:45], v5 offset:9216
  ds_read_b64_tr_b16 a[46:47], v5 offset:10240
  ds_read_b64_tr_b16 a[48:49], v4 offset:13824
  ds_read_b64_tr_b16 a[50:51], v4 offset:14848
  ds_read_b64_tr_b16 a[52:53], v5 offset:13824
  ds_read_b64_tr_b16 a[54:55], v5 offset:14848
  ds_read_b64_tr_b16 a[56:57], v2 offset:13824
  ds_read_b64_tr_b16 a[58:59], v2 offset:14848
  ds_read_b64_tr_b16 a[60:61], v3 offset:13824
  ds_read_b64_tr_b16 a[62:63], v3 offset:14848
  ds_read_b64_tr_b16 a[64:65], v2 offset:18432
  ds_read_b64_tr_b16 a[66:67], v2 offset:19456
  ds_read_b64_tr_b16 a[68:69], v3 offset:18432
  ds_read_b64_tr_b16 a[70:71], v3 offset:19456
  ds_read_b64_tr_b16 a[72:73], v4 offset:18432
  ds_read_b64_tr_b16 a[74:75], v4 offset:19456
  ds_read_b64_tr_b16 a[76:77], v5 offset:18432
  ds_read_b64_tr_b16 a[78:79], v5 offset:19456
  ds_read_b64_tr_b16 a[188:189], v4 offset:23040
  ds_read_b64_tr_b16 a[190:191], v4 offset:24064
  ds_read_b64_tr_b16 a[192:193], v5 offset:23040
  ds_read_b64_tr_b16 a[194:195], v5 offset:24064
  ds_read_b64_tr_b16 a[196:197], v2 offset:23040
  ds_read_b64_tr_b16 a[198:199], v2 offset:24064
  ds_read_b64_tr_b16 a[200:201], v3 offset:23040
  ds_read_b64_tr_b16 a[202:203], v3 offset:24064
  ds_read_b64_tr_b16 a[204:205], v2 offset:27648
  ds_read_b64_tr_b16 a[206:207], v2 offset:28672
  s_waitcnt vmcnt(12)
  s_atomic_swap_x2 s[0:1], s[12:13], s63 offset:0x40000
  ds_read_b64_tr_b16 a[208:209], v3 offset:27648
  ds_read_b64_tr_b16 a[210:211], v3 offset:28672
  ds_read_b64_tr_b16 a[212:213], v4 offset:27648
  ds_read_b64_tr_b16 a[214:215], v4 offset:28672
  ds_read_b64_tr_b16 a[216:217], v5 offset:27648
  ds_read_b64_tr_b16 a[218:219], v5 offset:28672
  ds_read_b64_tr_b16 a[220:221], v4 offset:32256
  ds_read_b64_tr_b16 a[222:223], v4 offset:33280
  ds_read_b64_tr_b16 a[224:225], v5 offset:32256
  ds_read_b64_tr_b16 a[226:227], v5 offset:33280
  ds_read_b64_tr_b16 a[228:229], v2 offset:32256
  ds_read_b64_tr_b16 a[230:231], v2 offset:33280
  ds_read_b64_tr_b16 a[232:233], v3 offset:32256
  ds_read_b64_tr_b16 a[234:235], v3 offset:33280
  ds_read_b64_tr_b16 a[236:237], v6 offset:0
  ds_read_b64_tr_b16 a[238:239], v6 offset:18432
  ds_read_b64_tr_b16 a[240:241], v7 offset:0
  ds_read_b64_tr_b16 a[242:243], v7 offset:18432
  ds_read_b64_tr_b16 a[244:245], v8 offset:0
  ds_read_b64_tr_b16 a[246:247], v8 offset:18432
  ds_read_b64_tr_b16 a[248:249], v9 offset:0
  ds_read_b64_tr_b16 a[250:251], v9 offset:18432
  s_add_u32 s37, s84, 131072
  buffer_load_dwordx2 v[182:183], v254, s[12:15], s37 offen sc1
  v_and_b32 v26, 15, v1
  v_lshrrev_b32 v27, 4, v1
  v_xor_b32 v28, v26, v27
  v_lshlrev_b32 v28, 4, v28
  v_lshl_add_u32 v28, v26, 8, v28
  v_add_u32 v11, s51, v28
  v_xor_b32 v12, 64, v11
  v_xor_b32 v13, 128, v11
  v_xor_b32 v14, 192, v11
  s_lshl_b32 s48, s28, 2
  v_add_u32 v27, s48, v27
  v_xor_b32 v28, v26, v27
  v_lshlrev_b32 v28, 4, v28
  v_lshl_add_u32 v17, v27, 8, v28
  v_add_u32 v18, 73728, v17
  v_mul_u32_u24 v27, 1152, v27
  v_lshl_add_u32 v19, v26, 3, v27
  s_waitcnt vmcnt(12) lgkmcnt(14)
  v_mfma_f32_16x16x32_bf16 v[48:51], a[0:3], a[116:119], 0
  v_mfma_f32_16x16x32_bf16 v[52:55], a[4:7], a[116:119], 0
  v_mfma_f32_16x16x32_bf16 v[56:59], a[8:11], a[116:119], 0
  v_mfma_f32_16x16x32_bf16 v[60:63], a[12:15], a[116:119], 0
  s_waitcnt vmcnt(11)
  v_mfma_f32_16x16x32_bf16 v[48:51], a[16:19], a[120:123], v[48:51]
  v_mfma_f32_16x16x32_bf16 v[52:55], a[20:23], a[120:123], v[52:55]
  v_mfma_f32_16x16x32_bf16 v[56:59], a[24:27], a[120:123], v[56:59]
  v_mfma_f32_16x16x32_bf16 v[60:63], a[28:31], a[120:123], v[60:63]
  s_waitcnt vmcnt(10)
  v_mfma_f32_16x16x32_bf16 v[48:51], a[32:35], a[124:127], v[48:51]
  v_mfma_f32_16x16x32_bf16 v[52:55], a[36:39], a[124:127], v[52:55]
  s_waitcnt vmcnt(0)
  v_cmp_ne_u64 vcc, v[182:183], v[232:233]
  v_mfma_f32_16x16x32_bf16 v[56:59], a[40:43], a[124:127], v[56:59]
  s_cbranch_vccnz L_o3s_38
L_o3r_39:
  s_add_u32 s80, s85, 73728
  v_mfma_f32_16x16x32_bf16 v[60:63], a[44:47], a[124:127], v[60:63]
  s_addc_u32 s81, s86, 0
  global_load_dwordx4 v[112:115], v15, s[80:81] offset:0 sc1
  v_mfma_f32_16x16x32_bf16 v[48:51], a[48:51], a[128:131], v[48:51]
  global_load_dwordx4 v[116:119], v15, s[80:81] offset:1024 sc1
  v_mfma_f32_16x16x32_bf16 v[52:55], a[52:55], a[128:131], v[52:55]
  global_load_dwordx4 v[120:123], v15, s[80:81] offset:2048 sc1
  v_mfma_f32_16x16x32_bf16 v[56:59], a[56:59], a[128:131], v[56:59]
  global_load_dwordx4 v[124:127], v15, s[80:81] offset:3072 sc1
  v_mfma_f32_16x16x32_bf16 v[60:63], a[60:63], a[128:131], v[60:63]
  global_load_dwordx4 v[128:131], v16, s[80:81] offset:0 sc1
  v_mfma_f32_16x16x32_bf16 v[48:51], a[64:67], a[132:135], v[48:51]
  global_load_dwordx4 v[132:135], v16, s[80:81] offset:1024 sc1
  v_mfma_f32_16x16x32_bf16 v[52:55], a[68:71], a[132:135], v[52:55]
  global_load_dwordx4 v[136:139], v16, s[80:81] offset:2048 sc1
  v_mfma_f32_16x16x32_bf16 v[56:59], a[72:75], a[132:135], v[56:59]
  global_load_dwordx4 v[140:143], v16, s[80:81] offset:3072 sc1
  v_mfma_f32_16x16x32_bf16 v[60:63], a[76:79], a[132:135], v[60:63]
  global_load_dword v144, v10, s[80:81] offset:0 sc1
  v_mfma_f32_16x16x32_bf16 v[48:51], a[188:191], a[136:139], v[48:51]
  global_load_dword v145, v10, s[80:81] offset:256 sc1
  v_mfma_f32_16x16x32_bf16 v[52:55], a[192:195], a[136:139], v[52:55]
  global_load_dword v146, v10, s[80:81] offset:512 sc1
  v_mfma_f32_16x16x32_bf16 v[56:59], a[196:199], a[136:139], v[56:59]
  global_load_dword v147, v10, s[80:81] offset:768 sc1
  v_mfma_f32_16x16x32_bf16 v[60:63], a[200:203], a[136:139], v[60:63]
  v_mfma_f32_16x16x32_bf16 v[48:51], a[204:207], a[140:143], v[48:51]
  v_mfma_f32_16x16x32_bf16 v[52:55], a[208:211], a[140:143], v[52:55]
  v_mfma_f32_16x16x32_bf16 v[56:59], a[212:215], a[140:143], v[56:59]
  v_mfma_f32_16x16x32_bf16 v[60:63], a[216:219], a[140:143], v[60:63]
  v_mfma_f32_16x16x32_bf16 v[48:51], a[220:223], a[144:147], v[48:51]
  s_waitcnt lgkmcnt(12)
  v_mfma_f32_16x16x32_bf16 v[52:55], a[224:227], a[144:147], v[52:55]
  s_waitcnt lgkmcnt(10)
  v_mfma_f32_16x16x32_bf16 v[56:59], a[228:231], a[144:147], v[56:59]
  s_waitcnt lgkmcnt(8)
  v_mfma_f32_16x16x32_bf16 v[60:63], a[232:235], a[144:147], v[60:63]
  s_waitcnt lgkmcnt(6)
  v_mfma_f32_16x16x32_bf16 v[48:51], a[236:239], a[148:151], v[48:51]
  s_waitcnt lgkmcnt(4)
  v_mfma_f32_16x16x32_bf16 v[52:55], a[240:243], a[148:151], v[52:55]
  s_waitcnt lgkmcnt(2)
  v_mfma_f32_16x16x32_bf16 v[56:59], a[244:247], a[148:151], v[56:59]
  s_waitcnt lgkmcnt(0)
  v_mfma_f32_16x16x32_bf16 v[60:63], a[248:251], a[148:151], v[60:63]
  s_nop 1
  ds_write_b128 v11, v[48:51] offset:4096
  s_nop 0
  ds_write_b128 v12, v[52:55] offset:4096
  s_nop 0
  ds_write_b128 v13, v[56:59] offset:4096
  s_nop 0
  ds_write_b128 v14, v[60:63] offset:4096
  buffer_load_dwordx2 v[228:229], v254, s[12:15], s84 offen sc1
  buffer_load_dwordx2 v[226:227], v254, s[12:15], s88 offen sc1
  s_waitcnt vmcnt(13)
  v_mfma_f32_16x16x32_bf16 v[80:83], a[0:3], v[112:115], 0
  v_mfma_f32_16x16x32_bf16 v[84:87], a[4:7], v[112:115], 0
  v_mfma_f32_16x16x32_bf16 v[88:91], a[8:11], v[112:115], 0
  v_mfma_f32_16x16x32_bf16 v[92:95], a[12:15], v[112:115], 0
  s_waitcnt vmcnt(12)
  v_mfma_f32_16x16x32_bf16 v[80:83], a[16:19], v[116:119], v[80:83]
  v_mfma_f32_16x16x32_bf16 v[84:87], a[20:23], v[116:119], v[84:87]
  v_mfma_f32_16x16x32_bf16 v[88:91], a[24:27], v[116:119], v[88:91]
  v_mfma_f32_16x16x32_bf16 v[92:95], a[28:31], v[116:119], v[92:95]
  s_waitcnt vmcnt(11)
  v_mfma_f32_16x16x32_bf16 v[80:83], a[32:35], v[120:123], v[80:83]
  v_mfma_f32_16x16x32_bf16 v[84:87], a[36:39], v[120:123], v[84:87]
  v_mfma_f32_16x16x32_bf16 v[88:91], a[40:43], v[120:123], v[88:91]
  v_mfma_f32_16x16x32_bf16 v[92:95], a[44:47], v[120:123], v[92:95]
  s_waitcnt vmcnt(10)
  v_mfma_f32_16x16x32_bf16 v[80:83], a[48:51], v[124:127], v[80:83]
  v_mfma_f32_16x16x32_bf16 v[84:87], a[52:55], v[124:127], v[84:87]
  v_mfma_f32_16x16x32_bf16 v[88:91], a[56:59], v[124:127], v[88:91]
  v_mfma_f32_16x16x32_bf16 v[92:95], a[60:63], v[124:127], v[92:95]
  s_waitcnt vmcnt(9)
  v_mfma_f32_16x16x32_bf16 v[80:83], a[64:67], v[128:131], v[80:83]
  v_mfma_f32_16x16x32_bf16 v[84:87], a[68:71], v[128:131], v[84:87]
  v_mfma_f32_16x16x32_bf16 v[88:91], a[72:75], v[128:131], v[88:91]
  v_mfma_f32_16x16x32_bf16 v[92:95], a[76:79], v[128:131], v[92:95]
  s_waitcnt vmcnt(1)
  v_cmp_ne_u64 vcc, v[228:229], v[232:233]
  v_mfma_f32_16x16x32_bf16 v[80:83], a[188:191], v[132:135], v[80:83]
  s_cbranch_vccnz L_o4s_32
L_o4r_33:
  s_add_u32 s80, s85, 0
  v_mfma_f32_16x16x32_bf16 v[84:87], a[192:195], v[132:135], v[84:87]
  s_addc_u32 s81, s86, 0
  global_load_dwordx4 v[184:187], v15, s[80:81] offset:0 sc1
  v_mfma_f32_16x16x32_bf16 v[88:91], a[196:199], v[132:135], v[88:91]
  global_load_dwordx4 v[188:191], v15, s[80:81] offset:1024 sc1
  v_mfma_f32_16x16x32_bf16 v[92:95], a[200:203], v[132:135], v[92:95]
  global_load_dwordx4 v[192:195], v15, s[80:81] offset:2048 sc1
  v_mfma_f32_16x16x32_bf16 v[80:83], a[204:207], v[136:139], v[80:83]
  global_load_dwordx4 v[196:199], v15, s[80:81] offset:3072 sc1
  v_mfma_f32_16x16x32_bf16 v[84:87], a[208:211], v[136:139], v[84:87]
  global_load_dwordx4 v[200:203], v16, s[80:81] offset:0 sc1
  v_mfma_f32_16x16x32_bf16 v[88:91], a[212:215], v[136:139], v[88:91]
  global_load_dwordx4 v[204:207], v16, s[80:81] offset:1024 sc1
  v_mfma_f32_16x16x32_bf16 v[92:95], a[216:219], v[136:139], v[92:95]
  global_load_dwordx4 v[208:211], v16, s[80:81] offset:2048 sc1
  v_mfma_f32_16x16x32_bf16 v[80:83], a[220:223], v[140:143], v[80:83]
  global_load_dwordx4 v[212:215], v16, s[80:81] offset:3072 sc1
  v_mfma_f32_16x16x32_bf16 v[84:87], a[224:227], v[140:143], v[84:87]
  global_load_dword v216, v10, s[80:81] offset:0 sc1
  v_mfma_f32_16x16x32_bf16 v[88:91], a[228:231], v[140:143], v[88:91]
  global_load_dword v217, v10, s[80:81] offset:256 sc1
  v_mfma_f32_16x16x32_bf16 v[92:95], a[232:235], v[140:143], v[92:95]
  global_load_dword v218, v10, s[80:81] offset:512 sc1
  v_mfma_f32_16x16x32_bf16 v[80:83], a[236:239], v[144:147], v[80:83]
  global_load_dword v219, v10, s[80:81] offset:768 sc1
  v_mfma_f32_16x16x32_bf16 v[84:87], a[240:243], v[144:147], v[84:87]
  s_waitcnt vmcnt(12)
  v_cmp_ne_u64 vcc, v[226:227], v[232:233]
  v_mfma_f32_16x16x32_bf16 v[88:91], a[244:247], v[144:147], v[88:91]
  s_cbranch_vccnz L_o2s_35
L_o2r_36:
  buffer_load_dwordx4 a[152:155], v15, s[92:95], 0 offen offset:0 sc1
  v_mfma_f32_16x16x32_bf16 v[92:95], a[248:251], v[144:147], v[92:95]
  buffer_load_dwordx4 a[156:159], v15, s[92:95], 0 offen offset:1024 sc1
  buffer_load_dwordx4 a[160:163], v15, s[92:95], 0 offen offset:2048 sc1
  buffer_load_dwordx4 a[164:167], v15, s[92:95], 0 offen offset:3072 sc1
  buffer_load_dwordx4 a[168:171], v16, s[92:95], 0 offen offset:0 sc1
  buffer_load_dwordx4 a[172:175], v16, s[92:95], 0 offen offset:1024 sc1
  buffer_load_dwordx4 a[176:179], v16, s[92:95], 0 offen offset:2048 sc1
  buffer_load_dwordx4 a[180:183], v16, s[92:95], 0 offen offset:3072 sc1
  buffer_load_dword a184, v10, s[92:95], 0 offen offset:0 sc1
  buffer_load_dword a185, v10, s[92:95], 0 offen offset:256 sc1
  buffer_load_dword a186, v10, s[92:95], 0 offen offset:512 sc1
  buffer_load_dword a187, v10, s[92:95], 0 offen offset:768 sc1
  ds_write_b128 v11, v[80:83] offset:12288
  ds_write_b128 v12, v[84:87] offset:12288
  ds_write_b128 v13, v[88:91] offset:12288
  ds_write_b128 v14, v[92:95] offset:12288
  s_waitcnt lgkmcnt(0)
  s_barrier
  ds_read_b128 v[48:51], v17 offset:4096
  ds_read_b128 v[52:55], v17 offset:40960
  ds_read_b128 v[56:59], v18 offset:4096
  ds_read_b128 v[60:63], v18 offset:40960
  ds_read_b128 v[80:83], v17 offset:12288
  ds_read_b128 v[84:87], v17 offset:49152
  ds_read_b128 v[88:91], v18 offset:12288
  ds_read_b128 v[92:95], v18 offset:49152
  s_waitcnt vmcnt(23)
  v_mfma_f32_16x16x32_bf16 v[96:99], a[0:3], v[184:187], 0
  s_waitcnt lgkmcnt(6)
  v_add_f32 v48, v48, v52
  v_mfma_f32_16x16x32_bf16 v[100:103], a[4:7], v[184:187], 0
  v_add_f32 v49, v49, v53
  v_mfma_f32_16x16x32_bf16 v[104:107], a[8:11], v[184:187], 0
  v_add_f32 v50, v50, v54
  v_mfma_f32_16x16x32_bf16 v[108:111], a[12:15], v[184:187], 0
  v_add_f32 v51, v51, v55
  s_waitcnt vmcnt(22)
  v_mfma_f32_16x16x32_bf16 v[96:99], a[16:19], v[188:191], v[96:99]
  s_waitcnt lgkmcnt(4)
  v_add_f32 v56, v56, v60
  v_mfma_f32_16x16x32_bf16 v[100:103], a[20:23], v[188:191], v[100:103]
  v_add_f32 v57, v57, v61
  v_mfma_f32_16x16x32_bf16 v[104:107], a[24:27], v[188:191], v[104:107]
  v_add_f32 v58, v58, v62
  v_mfma_f32_16x16x32_bf16 v[108:111], a[28:31], v[188:191], v[108:111]
  v_add_f32 v59, v59, v63
  s_waitcnt vmcnt(21)
  v_mfma_f32_16x16x32_bf16 v[96:99], a[32:35], v[192:195], v[96:99]
  v_add_f32 v48, v48, v56
  v_mfma_f32_16x16x32_bf16 v[100:103], a[36:39], v[192:195], v[100:103]
  v_add_f32 v49, v49, v57
  v_mfma_f32_16x16x32_bf16 v[104:107], a[40:43], v[192:195], v[104:107]
  v_add_f32 v50, v50, v58
  v_mfma_f32_16x16x32_bf16 v[108:111], a[44:47], v[192:195], v[108:111]
  v_add_f32 v51, v51, v59
  s_waitcnt vmcnt(20)
  v_mfma_f32_16x16x32_bf16 v[96:99], a[48:51], v[196:199], v[96:99]
  v_cvt_pk_bf16_f32 v48, v48, v49
  v_mfma_f32_16x16x32_bf16 v[100:103], a[52:55], v[196:199], v[100:103]
  v_cvt_pk_bf16_f32 v49, v50, v51
  v_mfma_f32_16x16x32_bf16 v[104:107], a[56:59], v[196:199], v[104:107]
  s_add_u32 s35, s87, 73728
  buffer_store_dwordx2 v[48:49], v19, s[20:23], s35 offen
  v_mfma_f32_16x16x32_bf16 v[108:111], a[60:63], v[196:199], v[108:111]
  s_waitcnt lgkmcnt(2)
  v_add_f32 v80, v80, v84
  s_waitcnt vmcnt(20)
  v_mfma_f32_16x16x32_bf16 v[96:99], a[64:67], v[200:203], v[96:99]
  v_add_f32 v81, v81, v85
  v_mfma_f32_16x16x32_bf16 v[100:103], a[68:71], v[200:203], v[100:103]
  v_add_f32 v82, v82, v86
  v_mfma_f32_16x16x32_bf16 v[104:107], a[72:75], v[200:203], v[104:107]
  v_add_f32 v83, v83, v87
  v_mfma_f32_16x16x32_bf16 v[108:111], a[76:79], v[200:203], v[108:111]
  s_waitcnt lgkmcnt(0)
  v_add_f32 v88, v88, v92
  s_waitcnt vmcnt(19)
  v_mfma_f32_16x16x32_bf16 v[96:99], a[188:191], v[204:207], v[96:99]
  v_add_f32 v89, v89, v93
  v_mfma_f32_16x16x32_bf16 v[100:103], a[192:195], v[204:207], v[100:103]
  v_add_f32 v90, v90, v94
  v_mfma_f32_16x16x32_bf16 v[104:107], a[196:199], v[204:207], v[104:107]
  v_add_f32 v91, v91, v95
  v_mfma_f32_16x16x32_bf16 v[108:111], a[200:203], v[204:207], v[108:111]
  v_add_f32 v80, v80, v88
  s_waitcnt vmcnt(18)
  v_mfma_f32_16x16x32_bf16 v[96:99], a[204:207], v[208:211], v[96:99]
  v_add_f32 v81, v81, v89
  v_mfma_f32_16x16x32_bf16 v[100:103], a[208:211], v[208:211], v[100:103]
  v_add_f32 v82, v82, v90
  v_mfma_f32_16x16x32_bf16 v[104:107], a[212:215], v[208:211], v[104:107]
  v_add_f32 v83, v83, v91
  v_mfma_f32_16x16x32_bf16 v[108:111], a[216:219], v[208:211], v[108:111]
  v_cvt_pk_bf16_f32 v80, v80, v81
  s_waitcnt vmcnt(17)
  v_mfma_f32_16x16x32_bf16 v[96:99], a[220:223], v[212:215], v[96:99]
  v_cvt_pk_bf16_f32 v81, v82, v83
  v_mfma_f32_16x16x32_bf16 v[100:103], a[224:227], v[212:215], v[100:103]
  s_add_u32 s35, s87, 36864
  buffer_store_dwordx2 v[80:81], v19, s[20:23], s35 offen
  v_mfma_f32_16x16x32_bf16 v[104:107], a[228:231], v[212:215], v[104:107]
  v_mfma_f32_16x16x32_bf16 v[108:111], a[232:235], v[212:215], v[108:111]
  s_waitcnt vmcnt(14)
  v_mfma_f32_16x16x32_bf16 v[96:99], a[236:239], v[216:219], v[96:99]
  v_mfma_f32_16x16x32_bf16 v[100:103], a[240:243], v[216:219], v[100:103]
  v_mfma_f32_16x16x32_bf16 v[104:107], a[244:247], v[216:219], v[104:107]
  v_mfma_f32_16x16x32_bf16 v[108:111], a[248:251], v[216:219], v[108:111]
  s_waitcnt vmcnt(13)
  v_mfma_f32_16x16x32_bf16 v[64:67], a[0:3], a[152:155], 0
  v_mfma_f32_16x16x32_bf16 v[68:71], a[4:7], a[152:155], 0
  v_mfma_f32_16x16x32_bf16 v[72:75], a[8:11], a[152:155], 0
  v_mfma_f32_16x16x32_bf16 v[76:79], a[12:15], a[152:155], 0
  ds_write_b128 v11, v[96:99] offset:16384
  s_waitcnt vmcnt(12)
  v_mfma_f32_16x16x32_bf16 v[64:67], a[16:19], a[156:159], v[64:67]
  v_mfma_f32_16x16x32_bf16 v[68:71], a[20:23], a[156:159], v[68:71]
  v_mfma_f32_16x16x32_bf16 v[72:75], a[24:27], a[156:159], v[72:75]
  ds_write_b128 v12, v[100:103] offset:16384
  v_mfma_f32_16x16x32_bf16 v[76:79], a[28:31], a[156:159], v[76:79]
  s_waitcnt vmcnt(11)
  v_mfma_f32_16x16x32_bf16 v[64:67], a[32:35], a[160:163], v[64:67]
  v_mfma_f32_16x16x32_bf16 v[68:71], a[36:39], a[160:163], v[68:71]
  ds_write_b128 v13, v[104:107] offset:16384
  v_mfma_f32_16x16x32_bf16 v[72:75], a[40:43], a[160:163], v[72:75]
  v_mfma_f32_16x16x32_bf16 v[76:79], a[44:47], a[160:163], v[76:79]
  s_waitcnt vmcnt(10)
  v_mfma_f32_16x16x32_bf16 v[64:67], a[48:51], a[164:167], v[64:67]
  ds_write_b128 v14, v[108:111] offset:16384
  v_mfma_f32_16x16x32_bf16 v[68:71], a[52:55], a[164:167], v[68:71]
  v_mfma_f32_16x16x32_bf16 v[72:75], a[56:59], a[164:167], v[72:75]
  v_mfma_f32_16x16x32_bf16 v[76:79], a[60:63], a[164:167], v[76:79]
  s_waitcnt vmcnt(9)
  v_mfma_f32_16x16x32_bf16 v[64:67], a[64:67], a[168:171], v[64:67]
  v_mfma_f32_16x16x32_bf16 v[68:71], a[68:71], a[168:171], v[68:71]
  v_mfma_f32_16x16x32_bf16 v[72:75], a[72:75], a[168:171], v[72:75]
  v_mfma_f32_16x16x32_bf16 v[76:79], a[76:79], a[168:171], v[76:79]
  s_waitcnt vmcnt(8)
  v_mfma_f32_16x16x32_bf16 v[64:67], a[188:191], a[172:175], v[64:67]
  v_mfma_f32_16x16x32_bf16 v[68:71], a[192:195], a[172:175], v[68:71]
  v_mfma_f32_16x16x32_bf16 v[72:75], a[196:199], a[172:175], v[72:75]
  v_mfma_f32_16x16x32_bf16 v[76:79], a[200:203], a[172:175], v[76:79]
  s_waitcnt vmcnt(7)
  v_mfma_f32_16x16x32_bf16 v[64:67], a[204:207], a[176:179], v[64:67]
  v_mfma_f32_16x16x32_bf16 v[68:71], a[208:211], a[176:179], v[68:71]
  v_mfma_f32_16x16x32_bf16 v[72:75], a[212:215], a[176:179], v[72:75]
  v_mfma_f32_16x16x32_bf16 v[76:79], a[216:219], a[176:179], v[76:79]
  s_waitcnt vmcnt(6)
  v_mfma_f32_16x16x32_bf16 v[64:67], a[220:223], a[180:183], v[64:67]
  v_mfma_f32_16x16x32_bf16 v[68:71], a[224:227], a[180:183], v[68:71]
  v_mfma_f32_16x16x32_bf16 v[72:75], a[228:231], a[180:183], v[72:75]
  v_mfma_f32_16x16x32_bf16 v[76:79], a[232:235], a[180:183], v[76:79]
  s_waitcnt vmcnt(2)
  v_mfma_f32_16x16x32_bf16 v[64:67], a[236:239], a[184:187], v[64:67]
  v_mfma_f32_16x16x32_bf16 v[68:71], a[240:243], a[184:187], v[68:71]
  v_mfma_f32_16x16x32_bf16 v[72:75], a[244:247], a[184:187], v[72:75]
  v_mfma_f32_16x16x32_bf16 v[76:79], a[248:251], a[184:187], v[76:79]
  s_nop 4
  ds_write_b128 v11, v[64:67] offset:8192
  ds_write_b128 v12, v[68:71] offset:8192
  ds_write_b128 v13, v[72:75] offset:8192
  ds_write_b128 v14, v[76:79] offset:8192
  s_waitcnt lgkmcnt(0)
  s_barrier
  ds_read_b128 v[96:99], v17 offset:16384
  ds_read_b128 v[100:103], v17 offset:53248
  ds_read_b128 v[104:107], v18 offset:16384
  ds_read_b128 v[108:111], v18 offset:53248
  ds_read_b128 v[64:67], v17 offset:8192
  ds_read_b128 v[68:71], v17 offset:45056
  ds_read_b128 v[72:75], v18 offset:8192
  ds_read_b128 v[76:79], v18 offset:45056
  s_waitcnt lgkmcnt(6)
  v_pk_add_f32 v[96:97], v[96:97], v[100:101]
  v_pk_add_f32 v[98:99], v[98:99], v[102:103]
  s_waitcnt lgkmcnt(4)
  v_pk_add_f32 v[104:105], v[104:105], v[108:109]
  v_pk_add_f32 v[106:107], v[106:107], v[110:111]
  v_pk_add_f32 v[96:97], v[96:97], v[104:105]
  v_pk_add_f32 v[98:99], v[98:99], v[106:107]
  v_cvt_pk_bf16_f32 v96, v96, v97
  v_cvt_pk_bf16_f32 v97, v98, v99
  s_add_u32 s35, s87, 0
  buffer_store_dwordx2 v[96:97], v19, s[20:23], s35 offen
  s_waitcnt lgkmcnt(2)
  v_pk_add_f32 v[64:65], v[64:65], v[68:69]
  v_pk_add_f32 v[66:67], v[66:67], v[70:71]
  s_waitcnt lgkmcnt(0)
  v_pk_add_f32 v[72:73], v[72:73], v[76:77]
  v_pk_add_f32 v[74:75], v[74:75], v[78:79]
  v_pk_add_f32 v[64:65], v[64:65], v[72:73]
  v_pk_add_f32 v[66:67], v[66:67], v[74:75]
  v_cvt_pk_bf16_f32 v64, v64, v65
  v_cvt_pk_bf16_f32 v65, v66, v67
  s_add_u32 s35, s91, 0
  buffer_store_dwordx2 v[64:65], v19, s[96:99], s35 offen
  s_branch L_fin
L_ool:
L_vs_1:
  s_mov_b32 s73, 1048576
L_vl_3:
  buffer_load_dwordx2 v[236:237], v239, s[12:15], 0 offen sc1
  s_sub_u32 s73, s73, 1
  s_cmp_eq_u32 s73, 0
  s_waitcnt vmcnt(0)
  s_cbranch_scc1 L_vr_2
  v_cmp_ne_u64 vcc, v[236:237], v[232:233]
  s_nop 0
  s_cbranch_vccnz L_vl_3
  s_branch L_vr_2
L_eps_4:
  s_mov_b32 s73, 1048576
L_epl_6:
  buffer_load_dwordx2 v[234:235], v238, s[12:15], 0 offen sc1
  s_sub_u32 s73, s73, 1
  s_cmp_eq_u32 s73, 0
  s_waitcnt vmcnt(0)
  s_cbranch_scc1 L_epr_5
  v_cmp_ne_u64 vcc, v[234:235], v[232:233]
  s_nop 0
  s_cbranch_vccnz L_epl_6
  s_branch L_epr_5
L_eps_7:
  s_mov_b32 s73, 1048576
L_epl_9:
  buffer_load_dwordx2 v[234:235], v238, s[12:15], 0 offen sc1
  s_sub_u32 s73, s73, 1
  s_cmp_eq_u32 s73, 0
  s_waitcnt vmcnt(0)
  s_cbranch_scc1 L_epr_8
  v_cmp_ne_u64 vcc, v[234:235], v[232:233]
  s_nop 0
  s_cbranch_vccnz L_epl_9
  s_branch L_epr_8
L_eps_10:
  s_mov_b32 s73, 1048576
L_epl_12:
  buffer_load_dwordx2 v[234:235], v238, s[12:15], 0 offen sc1
  s_sub_u32 s73, s73, 1
  s_cmp_eq_u32 s73, 0
  s_waitcnt vmcnt(0)
  s_cbranch_scc1 L_epr_11
  v_cmp_ne_u64 vcc, v[234:235], v[232:233]
  s_nop 0
  s_cbranch_vccnz L_epl_12
  s_branch L_epr_11
L_eps_13:
  s_mov_b32 s73, 1048576
L_epl_15:
  buffer_load_dwordx2 v[234:235], v238, s[12:15], 0 offen sc1
  s_sub_u32 s73, s73, 1
  s_cmp_eq_u32 s73, 0
  s_waitcnt vmcnt(0)
  s_cbranch_scc1 L_epr_14
  v_cmp_ne_u64 vcc, v[234:235], v[232:233]
  s_nop 0
  s_cbranch_vccnz L_epl_15
  s_branch L_epr_14
L_nop3:
  s_waitcnt vmcnt(0)
  s_add_u32 s35, s63, 262144
  buffer_store_dwordx2 v[232:233], v240, s[12:15], s35 offen sc1
  s_cmp_lg_u32 s2, 255
  s_cbranch_scc1 L_fin
  s_cmp_lg_u32 s28, 0
  s_cbranch_scc1 L_fin
  v_lshlrev_b32 v238, 5, v1
  v_add_u32 v238, 135168, v238
  buffer_load_dwordx2 v[234:235], v238, s[12:15], 0 offen sc1
  s_waitcnt vmcnt(0)
  v_cmp_ne_u64 vcc, v[234:235], v[232:233]
  s_nop 0
  s_cbranch_vccnz L_eps_4
L_epr_5:
  v_lshlrev_b32 v238, 5, v1
  v_add_u32 v238, 137216, v238
  buffer_load_dwordx2 v[234:235], v238, s[12:15], 0 offen sc1
  s_waitcnt vmcnt(0)
  v_cmp_ne_u64 vcc, v[234:235], v[232:233]
  s_nop 0
  s_cbranch_vccnz L_eps_7
L_epr_8:
  v_lshlrev_b32 v238, 5, v1
  v_add_u32 v238, 139264, v238
  buffer_load_dwordx2 v[234:235], v238, s[12:15], 0 offen sc1
  s_waitcnt vmcnt(0)
  v_cmp_ne_u64 vcc, v[234:235], v[232:233]
  s_nop 0
  s_cbranch_vccnz L_eps_10
L_epr_11:
  v_lshlrev_b32 v238, 5, v1
  v_add_u32 v238, 141312, v238
  buffer_load_dwordx2 v[234:235], v238, s[12:15], 0 offen sc1
  s_waitcnt vmcnt(0)
  v_cmp_ne_u64 vcc, v[234:235], v[232:233]
  s_nop 0
  s_cbranch_vccnz L_eps_13
L_epr_14:
  buffer_store_dwordx2 v[232:233], v240, s[12:15], 0 offen sc1
  s_branch L_fin
L_o1s_18:
  s_mov_b32 s73, 1048576
L_o1l_20:
  buffer_load_dwordx2 v[236:237], v254, s[12:15], s34 offen sc1
  s_sub_u32 s73, s73, 1
  s_cmp_eq_u32 s73, 0
  s_waitcnt vmcnt(0)
  s_cbranch_scc1 L_o1r_19
  v_cmp_ne_u64 vcc, v[236:237], v[232:233]
  s_nop 0
  s_cbranch_vccnz L_o1l_20
  s_branch L_o1r_19
L_w1_16:
  s_waitcnt vmcnt(0)
  s_atomic_swap_x2 s[0:1], s[12:13], s63 offset:0x40000
  buffer_load_dwordx2 v[236:237], v254, s[12:15], s34 offen sc1
  s_waitcnt vmcnt(0)
  v_cmp_ne_u64 vcc, v[236:237], v[232:233]
  s_nop 0
  s_cbranch_vccnz L_o1s_18
L_o1r_19:
  s_branch L_w1r_17
L_o5s_23:
  s_mov_b32 s73, 1048576
L_o5l_25:
  buffer_load_dwordx2 v[234:235], v254, s[12:15], s33 offen sc1
  s_sub_u32 s73, s73, 1
  s_cmp_eq_u32 s73, 0
  s_waitcnt vmcnt(0)
  s_cbranch_scc1 L_o5r_24
  v_cmp_ne_u64 vcc, v[234:235], v[232:233]
  s_nop 0
  s_cbranch_vccnz L_o5l_25
  s_branch L_o5r_24
L_w5_21:
  s_waitcnt vmcnt(0)
  s_atomic_swap_x2 s[0:1], s[12:13], s63 offset:0x40000
  buffer_load_dwordx2 v[234:235], v254, s[12:15], s33 offen sc1
  s_waitcnt vmcnt(0)
  v_cmp_ne_u64 vcc, v[234:235], v[232:233]
  s_nop 0
  s_cbranch_vccnz L_o5s_23
L_o5r_24:
  s_branch L_w5r_22
L_o4s_26:
  s_mov_b32 s73, 1048576
L_o4l_28:
  buffer_load_dwordx2 v[228:229], v254, s[12:15], s84 offen sc1
  s_sub_u32 s73, s73, 1
  s_cmp_eq_u32 s73, 0
  s_waitcnt vmcnt(0)
  s_cbranch_scc1 L_o4r_27
  v_cmp_ne_u64 vcc, v[228:229], v[232:233]
  s_nop 0
  s_cbranch_vccnz L_o4l_28
  s_branch L_o4r_27
L_o3s_29:
  s_mov_b32 s73, 1048576
L_o3l_31:
  buffer_load_dwordx2 v[182:183], v254, s[12:15], s37 offen sc1
  s_sub_u32 s73, s73, 1
  s_cmp_eq_u32 s73, 0
  s_waitcnt vmcnt(0)
  s_cbranch_scc1 L_o3r_30
  v_cmp_ne_u64 vcc, v[182:183], v[232:233]
  s_nop 0
  s_cbranch_vccnz L_o3l_31
  s_branch L_o3r_30
L_o4s_32:
  s_mov_b32 s73, 1048576
L_o4l_34:
  buffer_load_dwordx2 v[228:229], v254, s[12:15], s84 offen sc1
  s_sub_u32 s73, s73, 1
  s_cmp_eq_u32 s73, 0
  s_waitcnt vmcnt(0)
  s_cbranch_scc1 L_o4r_33
  v_cmp_ne_u64 vcc, v[228:229], v[232:233]
  s_nop 0
  s_cbranch_vccnz L_o4l_34
  s_branch L_o4r_33
L_o2s_35:
  s_mov_b32 s73, 1048576
L_o2l_37:
  buffer_load_dwordx2 v[226:227], v254, s[12:15], s88 offen sc1
  s_sub_u32 s73, s73, 1
  s_cmp_eq_u32 s73, 0
  s_waitcnt vmcnt(0)
  s_cbranch_scc1 L_o2r_36
  v_cmp_ne_u64 vcc, v[226:227], v[232:233]
  s_nop 0
  s_cbranch_vccnz L_o2l_37
  s_branch L_o2r_36
L_o3s_38:
  s_mov_b32 s73, 1048576
L_o3l_40:
  buffer_load_dwordx2 v[182:183], v254, s[12:15], s37 offen sc1
  s_sub_u32 s73, s73, 1
  s_cmp_eq_u32 s73, 0
  s_waitcnt vmcnt(0)
  s_cbranch_scc1 L_o3r_39
  v_cmp_ne_u64 vcc, v[182:183], v[232:233]
  s_nop 0
  s_cbranch_vccnz L_o3l_40
  s_branch L_o3r_39
L_fb_0:
  s_mov_b32 s27, 0
  s_mov_b32 s90, 0
  s_branch L_fb_save
L_fb_1:
  s_mov_b32 s27, 1
  s_mov_b32 s90, 1
  s_branch L_fb_save
L_fb_2:
  s_mov_b32 s27, 2
  s_mov_b32 s90, 2
  s_branch L_fb_save
L_fb_3:
  s_mov_b32 s27, 3
  s_mov_b32 s90, 3
  s_branch L_fb_save
L_fb_save:
  s_nop 15
  s_nop 7
  s_waitcnt vmcnt(0) lgkmcnt(0)
  s_lshl_b32 s11, s53, 14
  s_add_u32 s11, s11, 19922944
  s_add_u32 s3, s11, 0
  buffer_store_dwordx4 v[32:35], v22, s[12:15], s3 offen
  s_add_u32 s3, s11, 1024
  buffer_store_dwordx4 v[36:39], v22, s[12:15], s3 offen
  s_add_u32 s3, s11, 2048
  buffer_store_dwordx4 v[40:43], v22, s[12:15], s3 offen
  s_add_u32 s3, s11, 3072
  buffer_store_dwordx4 v[44:47], v22, s[12:15], s3 offen
  s_add_u32 s3, s11, 4096
  buffer_store_dwordx4 v[48:51], v22, s[12:15], s3 offen
  s_add_u32 s3, s11, 5120
  buffer_store_dwordx4 v[52:55], v22, s[12:15], s3 offen
  s_add_u32 s3, s11, 6144
  buffer_store_dwordx4 v[56:59], v22, s[12:15], s3 offen
  s_add_u32 s3, s11, 7168
  buffer_store_dwordx4 v[60:63], v22, s[12:15], s3 offen
  s_add_u32 s3, s11, 8192
  buffer_store_dwordx4 v[128:131], v22, s[12:15], s3 offen
  s_add_u32 s3, s11, 9216
  buffer_store_dwordx4 v[132:135], v22, s[12:15], s3 offen
  s_add_u32 s3, s11, 10240
  buffer_store_dwordx4 v[136:139], v22, s[12:15], s3 offen
  s_add_u32 s3, s11, 11264
  buffer_store_dwordx4 v[140:143], v22, s[12:15], s3 offen
  s_add_u32 s3, s11, 12288
  buffer_store_dwordx4 v[144:147], v22, s[12:15], s3 offen
  s_add_u32 s3, s11, 13312
  buffer_store_dwordx4 v[148:151], v22, s[12:15], s3 offen
  s_add_u32 s3, s11, 14336
  buffer_store_dwordx4 v[152:155], v22, s[12:15], s3 offen
  s_add_u32 s3, s11, 15360
  buffer_store_dwordx4 v[156:159], v22, s[12:15], s3 offen
  s_waitcnt vmcnt(0) lgkmcnt(0)
  s_and_b32 s3, s63, 0xffffffe0
  v_and_b32 v142, 3, v1
  v_lshlrev_b32 v142, 3, v142
  v_add_u32 v142, 131072, v142
  s_mov_b32 s73, 1048576
L_fb_poll:
  buffer_load_dwordx2 v[56:57], v142, s[12:15], s3 offen sc1
  s_sub_u32 s73, s73, 1
  s_cmp_eq_u32 s73, 0
  s_waitcnt vmcnt(0)
  s_cbranch_scc1 L_fb_go
  v_cmp_ne_u64 vcc, v[56:57], v[232:233]
  s_nop 0
  s_cbranch_vccnz L_fb_poll
L_fb_go:
  s_cmp_lg_u32 s27, 0
  s_cbranch_scc1 L_fb_q0
  v_accvgpr_read_b32 v136, a64
  v_accvgpr_read_b32 v137, a65
  v_accvgpr_read_b32 v138, a66
  v_accvgpr_read_b32 v139, a67
  v_mov_b32 v140, v168
L_fb_q0:
  s_cmp_lg_u32 s27, 1
  s_cbranch_scc1 L_fb_q1
  v_accvgpr_read_b32 v136, a68
  v_accvgpr_read_b32 v137, a69
  v_accvgpr_read_b32 v138, a70
  v_accvgpr_read_b32 v139, a71
  v_mov_b32 v140, v170
L_fb_q1:
  s_cmp_lg_u32 s27, 2
  s_cbranch_scc1 L_fb_q2
  v_accvgpr_read_b32 v136, a72
  v_accvgpr_read_b32 v137, a73
  v_accvgpr_read_b32 v138, a74
  v_accvgpr_read_b32 v139, a75
  v_mov_b32 v140, v172
L_fb_q2:
  s_cmp_lg_u32 s27, 3
  s_cbranch_scc1 L_fb_q3
  v_accvgpr_read_b32 v136, a76
  v_accvgpr_read_b32 v137, a77
  v_accvgpr_read_b32 v138, a78
  v_accvgpr_read_b32 v139, a79
  v_mov_b32 v140, v174
L_fb_q3:
  v_mov_b32 v62, 0xff800000
  v_mov_b32 v141, 0
  v_mov_b32 v61, 0
  v_mov_b32 v144, 0
  v_mov_b32 v145, 0
  v_mov_b32 v146, 0
  v_mov_b32 v147, 0
  v_mov_b32 v148, 0
  v_mov_b32 v149, 0
  v_mov_b32 v150, 0
  v_mov_b32 v151, 0
  v_mov_b32 v152, 0
  v_mov_b32 v153, 0
  v_mov_b32 v154, 0
  v_mov_b32 v155, 0
  v_mov_b32 v156, 0
  v_mov_b32 v157, 0
  v_mov_b32 v158, 0
  v_mov_b32 v159, 0
  s_mov_b32 s74, 0
L_fb_loop0:
  s_lshl_b32 s3, s29, 2
  s_add_u32 s3, s3, s27
  s_cmp_lt_u32 s3, s74
  s_cbranch_scc1 L_fb_end0
  s_sub_u32 s3, s3, s74
  s_lshr_b32 s35, s3, 2
  s_sub_u32 s35, s29, s35
  s_mul_i32 s35, s35, 655360
  s_sub_u32 s35, s54, s35
  s_and_b32 s3, s3, 3
  s_lshl_b32 s38, s3, 10
  s_add_u32 s38, s38, s35
  buffer_load_dwordx4 v[56:59], v19, s[12:15], s38 offen sc1
  buffer_load_dword v60, v20, s[12:15], s38 offen sc1
  buffer_load_dwordx4 v[128:131], v21, s[12:15], s38 offen sc1
  buffer_load_dwordx4 v[132:135], v21, s[12:15], s38 offen offset:512 sc1
  s_lshl_b32 s38, s74, 5
  v_add_u32 v142, s38, v246
  v_mov_b32 v49, 0xff800000
  s_movk_i32 s38, 256
  v_subrev_u32 v48, 0, v142
  v_cmp_gt_u32 vcc, s38, v48
  s_nop 1
  v_cndmask_b32 v32, v49, v240, vcc
  v_subrev_u32 v48, 1, v142
  v_cmp_gt_u32 vcc, s38, v48
  s_nop 1
  v_cndmask_b32 v33, v49, v240, vcc
  v_subrev_u32 v48, 2, v142
  v_cmp_gt_u32 vcc, s38, v48
  s_nop 1
  v_cndmask_b32 v34, v49, v240, vcc
  v_subrev_u32 v48, 3, v142
  v_cmp_gt_u32 vcc, s38, v48
  s_nop 1
  v_cndmask_b32 v35, v49, v240, vcc
  v_subrev_u32 v48, 8, v142
  v_cmp_gt_u32 vcc, s38, v48
  s_nop 1
  v_cndmask_b32 v36, v49, v240, vcc
  v_subrev_u32 v48, 9, v142
  v_cmp_gt_u32 vcc, s38, v48
  s_nop 1
  v_cndmask_b32 v37, v49, v240, vcc
  v_subrev_u32 v48, 10, v142
  v_cmp_gt_u32 vcc, s38, v48
  s_nop 1
  v_cndmask_b32 v38, v49, v240, vcc
  v_subrev_u32 v48, 11, v142
  v_cmp_gt_u32 vcc, s38, v48
  s_nop 1
  v_cndmask_b32 v39, v49, v240, vcc
  v_subrev_u32 v48, 16, v142
  v_cmp_gt_u32 vcc, s38, v48
  s_nop 1
  v_cndmask_b32 v40, v49, v240, vcc
  v_subrev_u32 v48, 17, v142
  v_cmp_gt_u32 vcc, s38, v48
  s_nop 1
  v_cndmask_b32 v41, v49, v240, vcc
  v_subrev_u32 v48, 18, v142
  v_cmp_gt_u32 vcc, s38, v48
  s_nop 1
  v_cndmask_b32 v42, v49, v240, vcc
  v_subrev_u32 v48, 19, v142
  v_cmp_gt_u32 vcc, s38, v48
  s_nop 1
  v_cndmask_b32 v43, v49, v240, vcc
  v_subrev_u32 v48, 24, v142
  v_cmp_gt_u32 vcc, s38, v48
  s_nop 1
  v_cndmask_b32 v44, v49, v240, vcc
  v_subrev_u32 v48, 25, v142
  v_cmp_gt_u32 vcc, s38, v48
  s_nop 1
  v_cndmask_b32 v45, v49, v240, vcc
  v_subrev_u32 v48, 26, v142
  v_cmp_gt_u32 vcc, s38, v48
  s_nop 1
  v_cndmask_b32 v46, v49, v240, vcc
  v_subrev_u32 v48, 27, v142
  v_cmp_gt_u32 vcc, s38, v48
  s_nop 1
  v_cndmask_b32 v47, v49, v240, vcc
  s_waitcnt vmcnt(3)
  s_nop 0
  v_mfma_f32_32x32x16_bf16 v[32:47], v[56:59], v[136:139], v[32:47]
  s_waitcnt vmcnt(2)
  v_mfma_f32_32x32x8_bf16 v[32:47], v[60:61], v[140:141], v[32:47]
  s_nop 11
  v_max_f32 v62, v62, v32
  v_max_f32 v62, v62, v33
  v_max_f32 v62, v62, v34
  v_max_f32 v62, v62, v35
  v_max_f32 v62, v62, v36
  v_max_f32 v62, v62, v37
  v_max_f32 v62, v62, v38
  v_max_f32 v62, v62, v39
  v_max_f32 v62, v62, v40
  v_max_f32 v62, v62, v41
  v_max_f32 v62, v62, v42
  v_max_f32 v62, v62, v43
  v_max_f32 v62, v62, v44
  v_max_f32 v62, v62, v45
  v_max_f32 v62, v62, v46
  v_max_f32 v62, v62, v47
  s_waitcnt vmcnt(0) lgkmcnt(0)
  s_nop 15
  s_nop 7
  s_add_u32 s74, s74, 1
  s_cmp_lt_u32 s74, 9
  s_cbranch_scc1 L_fb_loop0
L_fb_end0:
  v_mov_b32 v63, v62
  s_nop 1
  v_permlane32_swap_b32 v62, v63
  v_max_f32 v62, v62, v63
  s_mov_b32 s74, 0
L_fb_loop1:
  s_lshl_b32 s3, s29, 2
  s_add_u32 s3, s3, s27
  s_cmp_lt_u32 s3, s74
  s_cbranch_scc1 L_fb_end1
  s_sub_u32 s3, s3, s74
  s_lshr_b32 s35, s3, 2
  s_sub_u32 s35, s29, s35
  s_mul_i32 s35, s35, 655360
  s_sub_u32 s35, s54, s35
  s_and_b32 s3, s3, 3
  s_lshl_b32 s38, s3, 10
  s_add_u32 s38, s38, s35
  buffer_load_dwordx4 v[56:59], v19, s[12:15], s38 offen sc1
  buffer_load_dword v60, v20, s[12:15], s38 offen sc1
  buffer_load_dwordx4 v[128:131], v21, s[12:15], s38 offen sc1
  buffer_load_dwordx4 v[132:135], v21, s[12:15], s38 offen offset:512 sc1
  s_lshl_b32 s38, s74, 5
  v_add_u32 v142, s38, v246
  v_mov_b32 v49, 0xff800000
  s_movk_i32 s38, 256
  v_subrev_u32 v48, 0, v142
  v_cmp_gt_u32 vcc, s38, v48
  s_nop 1
  v_cndmask_b32 v32, v49, v240, vcc
  v_subrev_u32 v48, 1, v142
  v_cmp_gt_u32 vcc, s38, v48
  s_nop 1
  v_cndmask_b32 v33, v49, v240, vcc
  v_subrev_u32 v48, 2, v142
  v_cmp_gt_u32 vcc, s38, v48
  s_nop 1
  v_cndmask_b32 v34, v49, v240, vcc
  v_subrev_u32 v48, 3, v142
  v_cmp_gt_u32 vcc, s38, v48
  s_nop 1
  v_cndmask_b32 v35, v49, v240, vcc
  v_subrev_u32 v48, 8, v142
  v_cmp_gt_u32 vcc, s38, v48
  s_nop 1
  v_cndmask_b32 v36, v49, v240, vcc
  v_subrev_u32 v48, 9, v142
  v_cmp_gt_u32 vcc, s38, v48
  s_nop 1
  v_cndmask_b32 v37, v49, v240, vcc
  v_subrev_u32 v48, 10, v142
  v_cmp_gt_u32 vcc, s38, v48
  s_nop 1
  v_cndmask_b32 v38, v49, v240, vcc
  v_subrev_u32 v48, 11, v142
  v_cmp_gt_u32 vcc, s38, v48
  s_nop 1
  v_cndmask_b32 v39, v49, v240, vcc
  v_subrev_u32 v48, 16, v142
  v_cmp_gt_u32 vcc, s38, v48
  s_nop 1
  v_cndmask_b32 v40, v49, v240, vcc
  v_subrev_u32 v48, 17, v142
  v_cmp_gt_u32 vcc, s38, v48
  s_nop 1
  v_cndmask_b32 v41, v49, v240, vcc
  v_subrev_u32 v48, 18, v142
  v_cmp_gt_u32 vcc, s38, v48
  s_nop 1
  v_cndmask_b32 v42, v49, v240, vcc
  v_subrev_u32 v48, 19, v142
  v_cmp_gt_u32 vcc, s38, v48
  s_nop 1
  v_cndmask_b32 v43, v49, v240, vcc
  v_subrev_u32 v48, 24, v142
  v_cmp_gt_u32 vcc, s38, v48
  s_nop 1
  v_cndmask_b32 v44, v49, v240, vcc
  v_subrev_u32 v48, 25, v142
  v_cmp_gt_u32 vcc, s38, v48
  s_nop 1
  v_cndmask_b32 v45, v49, v240, vcc
  v_subrev_u32 v48, 26, v142
  v_cmp_gt_u32 vcc, s38, v48
  s_nop 1
  v_cndmask_b32 v46, v49, v240, vcc
  v_subrev_u32 v48, 27, v142
  v_cmp_gt_u32 vcc, s38, v48
  s_nop 1
  v_cndmask_b32 v47, v49, v240, vcc
  s_waitcnt vmcnt(3)
  s_nop 0
  v_mfma_f32_32x32x16_bf16 v[32:47], v[56:59], v[136:139], v[32:47]
  s_waitcnt vmcnt(2)
  v_mfma_f32_32x32x8_bf16 v[32:47], v[60:61], v[140:141], v[32:47]
  s_nop 11
  v_sub_f32 v32, v32, v62
  v_exp_f32 v32, v32
  v_sub_f32 v33, v33, v62
  v_exp_f32 v33, v33
  v_sub_f32 v34, v34, v62
  v_exp_f32 v34, v34
  v_sub_f32 v35, v35, v62
  v_exp_f32 v35, v35
  v_sub_f32 v36, v36, v62
  v_exp_f32 v36, v36
  v_sub_f32 v37, v37, v62
  v_exp_f32 v37, v37
  v_sub_f32 v38, v38, v62
  v_exp_f32 v38, v38
  v_sub_f32 v39, v39, v62
  v_exp_f32 v39, v39
  v_sub_f32 v40, v40, v62
  v_exp_f32 v40, v40
  v_sub_f32 v41, v41, v62
  v_exp_f32 v41, v41
  v_sub_f32 v42, v42, v62
  v_exp_f32 v42, v42
  v_sub_f32 v43, v43, v62
  v_exp_f32 v43, v43
  v_sub_f32 v44, v44, v62
  v_exp_f32 v44, v44
  v_sub_f32 v45, v45, v62
  v_exp_f32 v45, v45
  v_sub_f32 v46, v46, v62
  v_exp_f32 v46, v46
  v_sub_f32 v47, v47, v62
  v_exp_f32 v47, v47
  v_cvt_pk_bf16_f32 v48, v32, v33
  v_cvt_pk_bf16_f32 v49, v34, v35
  v_cvt_pk_bf16_f32 v50, v36, v37
  v_cvt_pk_bf16_f32 v51, v38, v39
  v_cvt_pk_bf16_f32 v52, v40, v41
  v_cvt_pk_bf16_f32 v53, v42, v43
  v_cvt_pk_bf16_f32 v54, v44, v45
  v_cvt_pk_bf16_f32 v55, v46, v47
  s_waitcnt vmcnt(1)
  v_mfma_f32_32x32x16_bf16 v[144:159], v[128:131], v[48:51], v[144:159]
  s_waitcnt vmcnt(0)
  v_mfma_f32_32x32x16_bf16 v[144:159], v[132:135], v[52:55], v[144:159]
  s_waitcnt vmcnt(0) lgkmcnt(0)
  s_nop 15
  s_nop 7
  s_add_u32 s74, s74, 1
  s_cmp_lt_u32 s74, 9
  s_cbranch_scc1 L_fb_loop1
L_fb_end1:
  s_cmp_lg_u32 s27, 0
  s_cbranch_scc1 L_fb_o0
  v_mov_b32 v64, v144
  v_mov_b32 v65, v145
  v_mov_b32 v66, v146
  v_mov_b32 v67, v147
  v_mov_b32 v68, v148
  v_mov_b32 v69, v149
  v_mov_b32 v70, v150
  v_mov_b32 v71, v151
  v_mov_b32 v72, v152
  v_mov_b32 v73, v153
  v_mov_b32 v74, v154
  v_mov_b32 v75, v155
  v_mov_b32 v76, v156
  v_mov_b32 v77, v157
  v_mov_b32 v78, v158
  v_mov_b32 v79, v159
L_fb_o0:
  s_cmp_lg_u32 s27, 1
  s_cbranch_scc1 L_fb_o1
  v_mov_b32 v80, v144
  v_mov_b32 v81, v145
  v_mov_b32 v82, v146
  v_mov_b32 v83, v147
  v_mov_b32 v84, v148
  v_mov_b32 v85, v149
  v_mov_b32 v86, v150
  v_mov_b32 v87, v151
  v_mov_b32 v88, v152
  v_mov_b32 v89, v153
  v_mov_b32 v90, v154
  v_mov_b32 v91, v155
  v_mov_b32 v92, v156
  v_mov_b32 v93, v157
  v_mov_b32 v94, v158
  v_mov_b32 v95, v159
L_fb_o1:
  s_cmp_lg_u32 s27, 2
  s_cbranch_scc1 L_fb_o2
  v_mov_b32 v96, v144
  v_mov_b32 v97, v145
  v_mov_b32 v98, v146
  v_mov_b32 v99, v147
  v_mov_b32 v100, v148
  v_mov_b32 v101, v149
  v_mov_b32 v102, v150
  v_mov_b32 v103, v151
  v_mov_b32 v104, v152
  v_mov_b32 v105, v153
  v_mov_b32 v106, v154
  v_mov_b32 v107, v155
  v_mov_b32 v108, v156
  v_mov_b32 v109, v157
  v_mov_b32 v110, v158
  v_mov_b32 v111, v159
L_fb_o2:
  s_cmp_lg_u32 s27, 3
  s_cbranch_scc1 L_fb_o3
  v_mov_b32 v112, v144
  v_mov_b32 v113, v145
  v_mov_b32 v114, v146
  v_mov_b32 v115, v147
  v_mov_b32 v116, v148
  v_mov_b32 v117, v149
  v_mov_b32 v118, v150
  v_mov_b32 v119, v151
  v_mov_b32 v120, v152
  v_mov_b32 v121, v153
  v_mov_b32 v122, v154
  v_mov_b32 v123, v155
  v_mov_b32 v124, v156
  v_mov_b32 v125, v157
  v_mov_b32 v126, v158
  v_mov_b32 v127, v159
L_fb_o3:
  v_rcp_f32 v26, v156
  s_mul_i32 s38, s27, 73728
  s_add_u32 s35, s68, s38
  s_add_u32 s38, s69, s38
  s_add_u32 s3, s11, 0
  buffer_load_dwordx4 v[32:35], v22, s[12:15], s3 offen sc1
  s_add_u32 s3, s11, 1024
  buffer_load_dwordx4 v[36:39], v22, s[12:15], s3 offen sc1
  s_add_u32 s3, s11, 2048
  buffer_load_dwordx4 v[40:43], v22, s[12:15], s3 offen sc1
  s_add_u32 s3, s11, 3072
  buffer_load_dwordx4 v[44:47], v22, s[12:15], s3 offen sc1
  s_add_u32 s3, s11, 4096
  buffer_load_dwordx4 v[48:51], v22, s[12:15], s3 offen sc1
  s_add_u32 s3, s11, 5120
  buffer_load_dwordx4 v[52:55], v22, s[12:15], s3 offen sc1
  s_add_u32 s3, s11, 6144
  buffer_load_dwordx4 v[56:59], v22, s[12:15], s3 offen sc1
  s_add_u32 s3, s11, 7168
  buffer_load_dwordx4 v[60:63], v22, s[12:15], s3 offen sc1
  s_add_u32 s3, s11, 8192
  buffer_load_dwordx4 v[128:131], v22, s[12:15], s3 offen sc1
  s_add_u32 s3, s11, 9216
  buffer_load_dwordx4 v[132:135], v22, s[12:15], s3 offen sc1
  s_add_u32 s3, s11, 10240
  buffer_load_dwordx4 v[136:139], v22, s[12:15], s3 offen sc1
  s_add_u32 s3, s11, 11264
  buffer_load_dwordx4 v[140:143], v22, s[12:15], s3 offen sc1
  s_add_u32 s3, s11, 12288
  buffer_load_dwordx4 v[144:147], v22, s[12:15], s3 offen sc1
  s_add_u32 s3, s11, 13312
  buffer_load_dwordx4 v[148:151], v22, s[12:15], s3 offen sc1
  s_add_u32 s3, s11, 14336
  buffer_load_dwordx4 v[152:155], v22, s[12:15], s3 offen sc1
  s_add_u32 s3, s11, 15360
  buffer_load_dwordx4 v[156:159], v22, s[12:15], s3 offen sc1
  s_waitcnt vmcnt(0) lgkmcnt(0)
  s_cmp_eq_u32 s90, 0
  s_cbranch_scc1 L_fbret_0
  s_cmp_eq_u32 s90, 1
  s_cbranch_scc1 L_fbret_1
  s_cmp_eq_u32 s90, 2
  s_cbranch_scc1 L_fbret_2
  s_branch L_fbret_3
L_code_end:
.if L_code_end - gated_mix__sliding_block__sliding_block__prompt_kernel < 32768 + 64
.error "code shorter than the prefetched range"
.endif
.section .rodata,"a"
.p2align 6
.amdhsa_kernel gated_mix__sliding_block__sliding_block__prompt_kernel
  .amdhsa_next_free_vgpr 512
  .amdhsa_next_free_sgpr 102
  .amdhsa_accum_offset 256
  .amdhsa_group_segment_fixed_size 0
  .amdhsa_kernarg_size 80
  .amdhsa_user_sgpr_count 2
  .amdhsa_user_sgpr_kernarg_segment_ptr 1
  .amdhsa_system_sgpr_workgroup_id_x 1
  .amdhsa_float_denorm_mode_32 3
.end_amdhsa_kernel
```
